```python
import torch

def _softmax(x, axis=-1):
    return torch.softmax(x, dim=axis)
def _gelu(x):
    return torch.nn.functional.gelu(x, approximate="tanh")
def _silu(x):
    return torch.nn.functional.silu(x)
def _sigmoid(x):
    return torch.sigmoid(x)
def _layernorm(x, axis=-1, eps=1e-5):
    m = x.mean(dim=axis, keepdim=True)
    v = x.var(dim=axis, keepdim=True, unbiased=False)
    return (x - m) / torch.sqrt(v + eps)
def _scatter_add(tgt, idx, src, axis=0):
    return tgt.clone().index_add_(axis, idx, src)
def _segment_sum(src, seg, n):
    out = torch.zeros((n,) + src.shape[1:], dtype=src.dtype)
    return out.index_add_(0, seg, src)
def _pad(x, pw):
    flat = tuple(v for pair in reversed(pw) for v in pair)
    return torch.nn.functional.pad(x, flat)

kernel_name = 'sequential_preLN__sliding_block__dense_activation_gelu__prompt'

def setup_inputs():

    _w = (lambda a: (lambda t: t.to(torch.bfloat16) if t.is_floating_point() else t)(torch.as_tensor(a)))
    def _A_setup():
        B, S, D = 1, 2048, 512
        return {
            "x": _w((lambda *s: torch.randn(*s, dtype=torch.bfloat16) * 0.05)(B, S, D)),
            "wqkv": _w((lambda *s: torch.randn(*s, dtype=torch.bfloat16) * 0.05)(D, 3 * D)),
            "wo": _w((lambda *s: torch.randn(*s, dtype=torch.bfloat16) * 0.05)(D, D)),
        }
    _A_in = _A_setup()

    def _B_setup():
        B, S, D, F = 1, 2048, 512, 1376
        return {
            "x": _w((lambda *s: torch.randn(*s, dtype=torch.bfloat16) * 0.05)(B, S, D)),
            "w1": _w((lambda *s: torch.randn(*s, dtype=torch.bfloat16) * 0.8)(D, F) * (D ** -0.5)),
            "b1": _w((lambda *s: torch.randn(*s, dtype=torch.bfloat16) * 0.8)(F) * 0.01),
            "w2": _w((lambda *s: torch.randn(*s, dtype=torch.bfloat16) * 0.8)(F, D) * (F ** -0.5)),
            "b2": _w((lambda *s: torch.randn(*s, dtype=torch.bfloat16) * 0.8)(D) * 0.01),
        }
    _B_in = _B_setup()

    return {
        "A_x": _A_in["x"],
        "A_wqkv": _A_in["wqkv"],
        "A_wo": _A_in["wo"],
        "B_x": _B_in["x"],
        "B_w1": _B_in["w1"],
        "B_b1": _B_in["b1"],
        "B_w2": _B_in["w2"],
        "B_b2": _B_in["b2"],
    }

def reference(A_x, A_wqkv, A_wo, B_x, B_w1, B_b1, B_w2, B_b2):
    def _A_ref(x, wqkv, wo):
        B, S, D = x.shape
        H = 32; Dh = D // H; W = 256
        qkv = (lambda x, *d: x.permute(*d))((x @ wqkv).reshape(B, S, 3, H, Dh), 2, 0, 3, 1, 4)
        q, k, v = qkv[0], qkv[1], qkv[2]
        scores = torch.einsum("bhqd,bhkd->bhqk", q, k) * (Dh ** -0.5)
        idx = torch.arange(S)
        mask = (idx[:, None] - idx[None, :] >= 0) & (idx[:, None] - idx[None, :] < W)
        scores = torch.where(mask[None, None], scores, -1e9)
        p = _softmax(scores, axis=-1)
        o = torch.einsum("bhqk,bhkd->bhqd", p, v)
        return (lambda x, *d: x.permute(*d))(o, 0, 2, 1, 3).reshape(B, S, D) @ wo

    def _B_ref(x, w1, b1, w2, b2):
        h = torch.einsum("bsd,df->bsf", x, w1) + b1
        h = _gelu(h)
        return torch.einsum("bsf,fd->bsd", h, w2) + b2

    x = A_x
    h = x + _A_ref(_layernorm(x, axis=-1), A_wqkv, A_wo)
    h2 = h + _B_ref(_layernorm(h, axis=-1), B_w1, B_b1, B_w2, B_b2)
    return h2
```

```asm
; @launch grid=(256,1,1) block=(512,1,1) lds=163840
.amdgcn_target "amdgcn-amd-amdhsa--gfx950"
.text
.globl sequential_preLN__sliding_block__dense_activation_gelu__prompt_kernel
.p2align 8
.type sequential_preLN__sliding_block__dense_activation_gelu__prompt_kernel,@function
sequential_preLN__sliding_block__dense_activation_gelu__prompt_kernel:
s_cmp_ge_u32 s2, 256
s_cbranch_scc1 L_exit
s_load_dwordx16 s[64:79], s[0:1], 0
s_load_dwordx4 s[80:83], s[0:1], 64
s_load_dwordx2 s[84:85], s[0:1], 80
v_and_b32 v1, 63, v0
v_lshrrev_b32 v2, 6, v0
s_and_b32 s6, s2, 7
v_readfirstlane_b32 s5, v2
s_lshr_b32 s7, s2, 3
s_and_b32 s4, s7, 7
s_lshr_b32 s7, s7, 3
s_lshl_b32 s3, s6, 2
s_add_u32 s3, s3, s7
s_waitcnt lgkmcnt(0)
s_mov_b32 s8, s84
s_mov_b32 s9, s85
s_mov_b32 s10, 268435456
s_mov_b32 s11, 0x20000
s_add_u32 s6, s84, 16793600
s_addc_u32 s7, s85, 0
s_load_dword s60, s[6:7], 0
s_mov_b32 s12, s66
s_mov_b32 s13, s67
s_mov_b32 s14, 1572864
s_mov_b32 s15, 0x20000
s_mov_b32 s16, s64
s_mov_b32 s17, s65
s_mov_b32 s18, 2097152
s_mov_b32 s19, 0x20000
s_and_b32 s26, s5, 1
s_bfe_u32 s28, s5, 0x10001
s_lshr_b32 s27, s5, 2
v_lshrrev_b32 v5, 4, v1
v_and_b32 v6, 15, v1
v_xor_b32 v6, v6, v5
v_lshlrev_b32 v6, 4, v6
v_lshlrev_b32 v5, 10, v5
v_add_u32 v32, v5, v6
v_xor_b32 v33, 64, v32
v_xor_b32 v34, 128, v32
v_xor_b32 v35, 192, v32
s_lshr_b32 s29, s5, 1
s_lshl_b32 s30, s3, 6
s_lshl_b32 s31, s26, 5
s_add_u32 s30, s30, s31
s_lshl_b32 s30, s30, 10
s_lshl_b32 s32, s29, 8
s_add_u32 s30, s30, s32
s_lshl_b32 s32, s29, 14
s_lshl_b32 s31, s31, 8
s_add_u32 s32, s32, s31
s_add_u32 s32, s32, 98304
s_add_u32 m0, s32, 0
s_add_u32 s31, s30, 0
buffer_load_dwordx4 v32, s[16:19], s31 offen lds
s_add_u32 m0, s32, 1024
s_add_u32 s31, s30, 4096
buffer_load_dwordx4 v33, s[16:19], s31 offen lds
s_add_u32 m0, s32, 2048
s_add_u32 s31, s30, 8192
buffer_load_dwordx4 v34, s[16:19], s31 offen lds
s_add_u32 m0, s32, 3072
s_add_u32 s31, s30, 12288
buffer_load_dwordx4 v35, s[16:19], s31 offen lds
s_add_u32 m0, s32, 4096
s_add_u32 s31, s30, 16384
buffer_load_dwordx4 v32, s[16:19], s31 offen lds
s_add_u32 m0, s32, 5120
s_add_u32 s31, s30, 20480
buffer_load_dwordx4 v33, s[16:19], s31 offen lds
s_add_u32 m0, s32, 6144
s_add_u32 s31, s30, 24576
buffer_load_dwordx4 v34, s[16:19], s31 offen lds
s_add_u32 m0, s32, 7168
s_add_u32 s31, s30, 28672
buffer_load_dwordx4 v35, s[16:19], s31 offen lds
s_and_b32 s6, s3, 3
s_lshl_b32 s6, s6, 3
s_add_u32 s6, s6, s4
s_lshl_b32 s6, s6, 3
s_add_u32 s6, s6, s5
s_and_b32 s7, s6, 127
s_mul_i32 s7, s7, 1536
s_cmp_ge_u32 s6, 128
s_cselect_b32 s6, 786432, 0
s_add_u32 s6, s6, s7
v_lshlrev_b32 v5, 7, v1
s_mov_b64 exec, 0xfff
buffer_load_dword v252, v5, s[12:15], s6 offen
s_mov_b64 exec, -1
s_barrier
v_lshrrev_b32 v21, 3, v1
v_mul_u32_u24 v21, 3072, v21
v_bfe_u32 v5, v1, 4, 1
v_lshlrev_b32 v5, 2, v5
v_xor_b32 v5, v5, v1
v_and_b32 v5, 7, v5
v_lshlrev_b32 v5, 4, v5
v_add_u32 v21, v21, v5
s_lshl_b32 s34, s4, 7
s_lshr_b32 s50, s5, 1
s_lshl_b32 s51, s50, 4
s_lshl_b32 s38, s26, 8
s_add_u32 s51, s51, s38
s_mul_i32 s51, s51, 3072
s_add_u32 s51, s51, s34
s_mul_i32 s50, s50, 12288
s_mul_i32 s38, s26, 6144
s_add_u32 s50, s50, s38
s_and_b32 s52, s5, 3
s_mul_i32 s53, s52, 49152
s_add_u32 s53, s53, s34
s_mul_i32 s52, s52, 12288
s_add_u32 m0, s50, 0
s_add_u32 s31, s51, 0
buffer_load_dwordx4 v21, s[12:15], s31 offen lds
s_add_u32 m0, s50, 1024
s_add_u32 s31, s51, 24576
buffer_load_dwordx4 v21, s[12:15], s31 offen lds
s_add_u32 m0, s50, 2048
s_add_u32 s31, s51, 1024
buffer_load_dwordx4 v21, s[12:15], s31 offen lds
s_add_u32 m0, s50, 3072
s_add_u32 s31, s51, 25600
buffer_load_dwordx4 v21, s[12:15], s31 offen lds
s_add_u32 m0, s50, 4096
s_add_u32 s31, s51, 2048
buffer_load_dwordx4 v21, s[12:15], s31 offen lds
s_add_u32 m0, s50, 5120
s_add_u32 s31, s51, 26624
buffer_load_dwordx4 v21, s[12:15], s31 offen lds
s_and_b32 s6, s3, 3
s_lshl_b32 s6, s6, 3
s_add_u32 s6, s6, s4
s_lshl_b32 s6, s6, 3
s_add_u32 s6, s6, s5
s_and_b32 s7, s6, 127
s_mul_i32 s7, s7, 4608
s_cmp_ge_u32 s6, 128
s_cselect_b32 s6, 786432, 0
s_add_u32 s6, s6, s7
s_add_u32 s6, s6, 196608
v_lshlrev_b32 v5, 7, v1
s_mov_b32 exec_hi, 0xf
buffer_load_dword v252, v5, s[12:15], s6 offen
s_mov_b64 exec, -1
v_lshrrev_b32 v5, 5, v1
v_lshlrev_b32 v5, 10, v5
v_bfe_u32 v6, v1, 2, 2
v_lshlrev_b32 v6, 7, v6
v_add_u32 v5, v5, v6
v_bfe_u32 v6, v1, 3, 1
v_xor_b32 v6, s28, v6
v_lshlrev_b32 v6, 6, v6
v_add_u32 v5, v5, v6
v_bfe_u32 v6, v1, 4, 1
v_lshlrev_b32 v6, 5, v6
v_add_u32 v5, v5, v6
v_and_b32 v6, 3, v1
v_lshlrev_b32 v6, 3, v6
v_add_u32 v5, v5, v6
s_mul_i32 s38, s27, 6144
v_add_u32 v2, s38, v5
v_add_u32 v3, 49152, v2
v_add_u32 v4, 98304, v2
v_mov_b32 v128, 0
v_mov_b32 v129, 0
v_mov_b32 v130, 0
v_mov_b32 v131, 0
v_mov_b32 v132, 0
v_mov_b32 v133, 0
v_mov_b32 v134, 0
v_mov_b32 v135, 0
v_mov_b32 v136, 0
v_mov_b32 v137, 0
v_mov_b32 v138, 0
v_mov_b32 v139, 0
v_mov_b32 v140, 0
v_mov_b32 v141, 0
v_mov_b32 v142, 0
v_mov_b32 v143, 0
v_mov_b32 v144, 0
v_mov_b32 v145, 0
v_mov_b32 v146, 0
v_mov_b32 v147, 0
v_mov_b32 v148, 0
v_mov_b32 v149, 0
v_mov_b32 v150, 0
v_mov_b32 v151, 0
v_mov_b32 v152, 0
v_mov_b32 v153, 0
v_mov_b32 v154, 0
v_mov_b32 v155, 0
v_mov_b32 v156, 0
v_mov_b32 v157, 0
v_mov_b32 v158, 0
v_mov_b32 v159, 0
v_mov_b32 v160, 0
v_mov_b32 v161, 0
v_mov_b32 v162, 0
v_mov_b32 v163, 0
v_mov_b32 v164, 0
v_mov_b32 v165, 0
v_mov_b32 v166, 0
v_mov_b32 v167, 0
v_mov_b32 v168, 0
v_mov_b32 v169, 0
v_mov_b32 v170, 0
v_mov_b32 v171, 0
v_mov_b32 v172, 0
v_mov_b32 v173, 0
v_mov_b32 v174, 0
v_mov_b32 v175, 0
v_mov_b32 v16, 0
v_mov_b32 v17, 0
v_mov_b32 v18, 0
v_mov_b32 v19, 0
v_mov_b32 v20, 0
s_mov_b32 s39, 0x3f803f80
v_and_b32 v5, 31, v1
v_lshlrev_b32 v6, 8, v5
v_and_b32 v5, 15, v5
v_lshrrev_b32 v7, 5, v1
v_xor_b32 v5, v5, v7
v_lshlrev_b32 v5, 4, v5
v_add_u32 v5, v5, v6
s_lshl_b32 s38, s27, 15
s_lshl_b32 s40, s26, 13
s_add_u32 s38, s38, s40
s_add_u32 s38, s38, 98304
v_add_u32 v24, s38, v5
v_xor_b32 v25, 32, v24
v_xor_b32 v26, 64, v24
v_xor_b32 v27, 96, v24
v_xor_b32 v28, 128, v24
v_xor_b32 v29, 160, v24
v_xor_b32 v30, 192, v24
v_xor_b32 v31, 224, v24
s_waitcnt vmcnt(8)
s_barrier
ds_read_b128 v[64:67], v24 offset:0
ds_read_b128 v[68:71], v25 offset:0
ds_read_b128 v[72:75], v26 offset:0
ds_read_b128 v[76:79], v27 offset:0
ds_read_b128 v[80:83], v28 offset:0
ds_read_b128 v[84:87], v29 offset:0
ds_read_b128 v[88:91], v30 offset:0
ds_read_b128 v[92:95], v31 offset:0
ds_read_b128 v[96:99], v24 offset:16384
ds_read_b128 v[100:103], v25 offset:16384
ds_read_b128 v[104:107], v26 offset:16384
ds_read_b128 v[108:111], v27 offset:16384
ds_read_b128 v[112:115], v28 offset:16384
ds_read_b128 v[116:119], v29 offset:16384
ds_read_b128 v[120:123], v30 offset:16384
ds_read_b128 v[124:127], v31 offset:16384
s_waitcnt lgkmcnt(0)
s_add_u32 s60, s60, 1
s_mov_b32 s100, s60
s_mov_b32 s101, s60
s_barrier
s_cmp_eq_u32 s28, 1
s_cbranch_scc1 L_c1_1
v_dot2c_f32_bf16 v16, s39, v64
v_dot2c_f32_bf16 v17, v64, v64
v_dot2c_f32_bf16 v16, s39, v65
v_dot2c_f32_bf16 v17, v65, v65
v_dot2c_f32_bf16 v16, s39, v66
v_dot2c_f32_bf16 v17, v66, v66
v_dot2c_f32_bf16 v16, s39, v67
v_dot2c_f32_bf16 v17, v67, v67
v_dot2c_f32_bf16 v16, s39, v68
v_dot2c_f32_bf16 v17, v68, v68
v_dot2c_f32_bf16 v16, s39, v69
v_dot2c_f32_bf16 v17, v69, v69
v_dot2c_f32_bf16 v16, s39, v70
v_dot2c_f32_bf16 v17, v70, v70
v_dot2c_f32_bf16 v16, s39, v71
v_dot2c_f32_bf16 v17, v71, v71
v_dot2c_f32_bf16 v16, s39, v72
v_dot2c_f32_bf16 v17, v72, v72
v_dot2c_f32_bf16 v16, s39, v73
v_dot2c_f32_bf16 v17, v73, v73
v_dot2c_f32_bf16 v16, s39, v74
v_dot2c_f32_bf16 v17, v74, v74
v_dot2c_f32_bf16 v16, s39, v75
v_dot2c_f32_bf16 v17, v75, v75
v_dot2c_f32_bf16 v16, s39, v76
v_dot2c_f32_bf16 v17, v76, v76
v_dot2c_f32_bf16 v16, s39, v77
v_dot2c_f32_bf16 v17, v77, v77
v_dot2c_f32_bf16 v16, s39, v78
v_dot2c_f32_bf16 v17, v78, v78
v_dot2c_f32_bf16 v16, s39, v79
v_dot2c_f32_bf16 v17, v79, v79
v_dot2c_f32_bf16 v16, s39, v80
v_dot2c_f32_bf16 v17, v80, v80
v_dot2c_f32_bf16 v16, s39, v81
v_dot2c_f32_bf16 v17, v81, v81
v_dot2c_f32_bf16 v16, s39, v82
v_dot2c_f32_bf16 v17, v82, v82
v_dot2c_f32_bf16 v16, s39, v83
v_dot2c_f32_bf16 v17, v83, v83
v_dot2c_f32_bf16 v16, s39, v84
v_dot2c_f32_bf16 v17, v84, v84
v_dot2c_f32_bf16 v16, s39, v85
v_dot2c_f32_bf16 v17, v85, v85
v_dot2c_f32_bf16 v16, s39, v86
v_dot2c_f32_bf16 v17, v86, v86
v_dot2c_f32_bf16 v16, s39, v87
v_dot2c_f32_bf16 v17, v87, v87
v_dot2c_f32_bf16 v16, s39, v88
v_dot2c_f32_bf16 v17, v88, v88
v_dot2c_f32_bf16 v16, s39, v89
v_dot2c_f32_bf16 v17, v89, v89
v_dot2c_f32_bf16 v16, s39, v90
v_dot2c_f32_bf16 v17, v90, v90
v_dot2c_f32_bf16 v16, s39, v91
v_dot2c_f32_bf16 v17, v91, v91
v_dot2c_f32_bf16 v16, s39, v92
v_dot2c_f32_bf16 v17, v92, v92
v_dot2c_f32_bf16 v16, s39, v93
v_dot2c_f32_bf16 v17, v93, v93
v_dot2c_f32_bf16 v16, s39, v94
v_dot2c_f32_bf16 v17, v94, v94
v_dot2c_f32_bf16 v16, s39, v95
v_dot2c_f32_bf16 v17, v95, v95
s_branch L_cj_2
L_c1_1:
v_dot2c_f32_bf16 v16, s39, v96
v_dot2c_f32_bf16 v17, v96, v96
v_dot2c_f32_bf16 v16, s39, v97
v_dot2c_f32_bf16 v17, v97, v97
v_dot2c_f32_bf16 v16, s39, v98
v_dot2c_f32_bf16 v17, v98, v98
v_dot2c_f32_bf16 v16, s39, v99
v_dot2c_f32_bf16 v17, v99, v99
v_dot2c_f32_bf16 v16, s39, v100
v_dot2c_f32_bf16 v17, v100, v100
v_dot2c_f32_bf16 v16, s39, v101
v_dot2c_f32_bf16 v17, v101, v101
v_dot2c_f32_bf16 v16, s39, v102
v_dot2c_f32_bf16 v17, v102, v102
v_dot2c_f32_bf16 v16, s39, v103
v_dot2c_f32_bf16 v17, v103, v103
v_dot2c_f32_bf16 v16, s39, v104
v_dot2c_f32_bf16 v17, v104, v104
v_dot2c_f32_bf16 v16, s39, v105
v_dot2c_f32_bf16 v17, v105, v105
v_dot2c_f32_bf16 v16, s39, v106
v_dot2c_f32_bf16 v17, v106, v106
v_dot2c_f32_bf16 v16, s39, v107
v_dot2c_f32_bf16 v17, v107, v107
v_dot2c_f32_bf16 v16, s39, v108
v_dot2c_f32_bf16 v17, v108, v108
v_dot2c_f32_bf16 v16, s39, v109
v_dot2c_f32_bf16 v17, v109, v109
v_dot2c_f32_bf16 v16, s39, v110
v_dot2c_f32_bf16 v17, v110, v110
v_dot2c_f32_bf16 v16, s39, v111
v_dot2c_f32_bf16 v17, v111, v111
v_dot2c_f32_bf16 v16, s39, v112
v_dot2c_f32_bf16 v17, v112, v112
v_dot2c_f32_bf16 v16, s39, v113
v_dot2c_f32_bf16 v17, v113, v113
v_dot2c_f32_bf16 v16, s39, v114
v_dot2c_f32_bf16 v17, v114, v114
v_dot2c_f32_bf16 v16, s39, v115
v_dot2c_f32_bf16 v17, v115, v115
v_dot2c_f32_bf16 v16, s39, v116
v_dot2c_f32_bf16 v17, v116, v116
v_dot2c_f32_bf16 v16, s39, v117
v_dot2c_f32_bf16 v17, v117, v117
v_dot2c_f32_bf16 v16, s39, v118
v_dot2c_f32_bf16 v17, v118, v118
v_dot2c_f32_bf16 v16, s39, v119
v_dot2c_f32_bf16 v17, v119, v119
v_dot2c_f32_bf16 v16, s39, v120
v_dot2c_f32_bf16 v17, v120, v120
v_dot2c_f32_bf16 v16, s39, v121
v_dot2c_f32_bf16 v17, v121, v121
v_dot2c_f32_bf16 v16, s39, v122
v_dot2c_f32_bf16 v17, v122, v122
v_dot2c_f32_bf16 v16, s39, v123
v_dot2c_f32_bf16 v17, v123, v123
v_dot2c_f32_bf16 v16, s39, v124
v_dot2c_f32_bf16 v17, v124, v124
v_dot2c_f32_bf16 v16, s39, v125
v_dot2c_f32_bf16 v17, v125, v125
v_dot2c_f32_bf16 v16, s39, v126
v_dot2c_f32_bf16 v17, v126, v126
v_dot2c_f32_bf16 v16, s39, v127
v_dot2c_f32_bf16 v17, v127, v127
L_cj_2:
v_lshlrev_b32 v7, 3, v1
s_lshl_b32 s38, s5, 9
s_add_u32 s38, s38, 147456
v_add_u32 v7, s38, v7
ds_write_b64 v7, v[16:17]
v_and_b32 v7, 31, v1
v_lshlrev_b32 v7, 3, v7
s_lshl_b32 s38, s26, 9
s_add_u32 s38, s38, 147456
v_add_u32 v7, s38, v7
s_waitcnt vmcnt(1)
s_waitcnt lgkmcnt(0)
s_barrier
s_cmp_lt_u32 s5, 4
s_cbranch_scc1 L_gb_3
s_add_u32 m0, s52, 49152
s_add_u32 s31, s53, 196608
buffer_load_dwordx4 v21, s[12:15], s31 offen lds
s_add_u32 m0, s52, 50176
s_add_u32 s31, s53, 221184
buffer_load_dwordx4 v21, s[12:15], s31 offen lds
s_add_u32 m0, s52, 51200
s_add_u32 s31, s53, 197632
buffer_load_dwordx4 v21, s[12:15], s31 offen lds
s_add_u32 m0, s52, 52224
s_add_u32 s31, s53, 222208
buffer_load_dwordx4 v21, s[12:15], s31 offen lds
s_add_u32 m0, s52, 53248
s_add_u32 s31, s53, 198656
buffer_load_dwordx4 v21, s[12:15], s31 offen lds
s_add_u32 m0, s52, 54272
s_add_u32 s31, s53, 223232
buffer_load_dwordx4 v21, s[12:15], s31 offen lds
s_add_u32 m0, s52, 55296
s_add_u32 s31, s53, 983040
buffer_load_dwordx4 v21, s[12:15], s31 offen lds
s_add_u32 m0, s52, 56320
s_add_u32 s31, s53, 1007616
buffer_load_dwordx4 v21, s[12:15], s31 offen lds
s_add_u32 m0, s52, 57344
s_add_u32 s31, s53, 984064
buffer_load_dwordx4 v21, s[12:15], s31 offen lds
s_add_u32 m0, s52, 58368
s_add_u32 s31, s53, 1008640
buffer_load_dwordx4 v21, s[12:15], s31 offen lds
s_add_u32 m0, s52, 59392
s_add_u32 s31, s53, 985088
buffer_load_dwordx4 v21, s[12:15], s31 offen lds
s_add_u32 m0, s52, 60416
s_add_u32 s31, s53, 1009664
buffer_load_dwordx4 v21, s[12:15], s31 offen lds
L_gb_3:
ds_read_b64 v[232:233], v7 offset:0
ds_read_b64 v[234:235], v7 offset:256
ds_read_b64 v[236:237], v7 offset:1024
ds_read_b64 v[238:239], v7 offset:1280
ds_read_b64 v[240:241], v7 offset:2048
ds_read_b64 v[242:243], v7 offset:2304
ds_read_b64 v[244:245], v7 offset:3072
ds_read_b64 v[246:247], v7 offset:3328
s_waitcnt lgkmcnt(0)
v_pk_add_f32 v[232:233], v[232:233], v[234:235]
v_pk_add_f32 v[236:237], v[236:237], v[238:239]
v_pk_add_f32 v[240:241], v[240:241], v[242:243]
v_pk_add_f32 v[244:245], v[244:245], v[246:247]
v_pk_add_f32 v[232:233], v[232:233], v[236:237]
v_pk_add_f32 v[240:241], v[240:241], v[244:245]
v_pk_add_f32 v[232:233], v[232:233], v[240:241]
v_mul_f32 v232, 0x3b000000, v232
v_mul_f32 v233, 0x3b000000, v233
v_fma_f32 v233, -v232, v232, v233
v_max_f32 v233, 0, v233
v_add_f32 v233, 0x3727c5ac, v233
v_rsq_f32 v234, v233
s_nop 0
v_mov_b32 v235, v234
v_mul_f32 v236, v232, v234
v_sub_f32 v236, 0, v236
v_mov_b32 v237, v236
v_lshlrev_b32 v200, 16, v64
v_and_b32 v201, 0xffff0000, v64
v_lshlrev_b32 v202, 16, v65
v_and_b32 v203, 0xffff0000, v65
v_lshlrev_b32 v204, 16, v66
v_and_b32 v205, 0xffff0000, v66
v_lshlrev_b32 v206, 16, v67
v_and_b32 v207, 0xffff0000, v67
v_pk_fma_f32 v[200:201], v[200:201], v[234:235], v[236:237]
v_pk_fma_f32 v[202:203], v[202:203], v[234:235], v[236:237]
v_pk_fma_f32 v[204:205], v[204:205], v[234:235], v[236:237]
v_pk_fma_f32 v[206:207], v[206:207], v[234:235], v[236:237]
v_cvt_pk_bf16_f32 v64, v200, v201
v_cvt_pk_bf16_f32 v65, v202, v203
v_cvt_pk_bf16_f32 v66, v204, v205
v_cvt_pk_bf16_f32 v67, v206, v207
v_lshlrev_b32 v208, 16, v68
v_and_b32 v209, 0xffff0000, v68
v_lshlrev_b32 v210, 16, v69
v_and_b32 v211, 0xffff0000, v69
v_lshlrev_b32 v212, 16, v70
v_and_b32 v213, 0xffff0000, v70
v_lshlrev_b32 v214, 16, v71
v_and_b32 v215, 0xffff0000, v71
v_pk_fma_f32 v[208:209], v[208:209], v[234:235], v[236:237]
v_pk_fma_f32 v[210:211], v[210:211], v[234:235], v[236:237]
v_pk_fma_f32 v[212:213], v[212:213], v[234:235], v[236:237]
v_pk_fma_f32 v[214:215], v[214:215], v[234:235], v[236:237]
v_cvt_pk_bf16_f32 v68, v208, v209
v_cvt_pk_bf16_f32 v69, v210, v211
v_cvt_pk_bf16_f32 v70, v212, v213
v_cvt_pk_bf16_f32 v71, v214, v215
ds_read_b64_tr_b16 v[176:177], v2 offset:0
ds_read_b64_tr_b16 v[178:179], v2 offset:512
ds_read_b64_tr_b16 v[180:181], v2 offset:2048
ds_read_b64_tr_b16 v[182:183], v2 offset:2560
ds_read_b64_tr_b16 v[184:185], v2 offset:4096
ds_read_b64_tr_b16 v[186:187], v2 offset:4608
ds_read_b64_tr_b16 v[188:189], v2 offset:12288
ds_read_b64_tr_b16 v[190:191], v2 offset:12800
ds_read_b64_tr_b16 v[192:193], v2 offset:14336
ds_read_b64_tr_b16 v[194:195], v2 offset:14848
ds_read_b64_tr_b16 v[196:197], v2 offset:16384
ds_read_b64_tr_b16 v[198:199], v2 offset:16896
s_waitcnt lgkmcnt(6)
v_mfma_f32_32x32x16_bf16 v[128:143], v[176:179], v[64:67], v[128:143]
v_lshlrev_b32 v200, 16, v72
v_and_b32 v201, 0xffff0000, v72
v_lshlrev_b32 v202, 16, v73
v_and_b32 v203, 0xffff0000, v73
v_lshlrev_b32 v204, 16, v74
v_and_b32 v205, 0xffff0000, v74
v_lshlrev_b32 v206, 16, v75
v_and_b32 v207, 0xffff0000, v75
v_mfma_f32_32x32x16_bf16 v[144:159], v[180:183], v[64:67], v[144:159]
v_fma_f32 v200, v200, v234, v236
v_fma_f32 v201, v201, v234, v236
v_fma_f32 v202, v202, v234, v236
v_fma_f32 v203, v203, v234, v236
v_fma_f32 v204, v204, v234, v236
v_fma_f32 v205, v205, v234, v236
v_fma_f32 v206, v206, v234, v236
v_fma_f32 v207, v207, v234, v236
v_mfma_f32_32x32x16_bf16 v[160:175], v[64:67], v[184:187], v[160:175]
v_cvt_pk_bf16_f32 v72, v200, v201
v_cvt_pk_bf16_f32 v73, v202, v203
v_cvt_pk_bf16_f32 v74, v204, v205
v_cvt_pk_bf16_f32 v75, v206, v207
ds_read_b64_tr_b16 v[176:177], v2 offset:24576
ds_read_b64_tr_b16 v[178:179], v2 offset:25088
ds_read_b64_tr_b16 v[180:181], v2 offset:26624
ds_read_b64_tr_b16 v[182:183], v2 offset:27136
ds_read_b64_tr_b16 v[184:185], v2 offset:28672
ds_read_b64_tr_b16 v[186:187], v2 offset:29184
s_waitcnt lgkmcnt(6)
v_mfma_f32_32x32x16_bf16 v[128:143], v[188:191], v[68:71], v[128:143]
v_lshlrev_b32 v208, 16, v76
v_and_b32 v209, 0xffff0000, v76
v_lshlrev_b32 v210, 16, v77
v_and_b32 v211, 0xffff0000, v77
v_lshlrev_b32 v212, 16, v78
v_and_b32 v213, 0xffff0000, v78
v_lshlrev_b32 v214, 16, v79
v_and_b32 v215, 0xffff0000, v79
v_mfma_f32_32x32x16_bf16 v[144:159], v[192:195], v[68:71], v[144:159]
v_fma_f32 v208, v208, v234, v236
v_fma_f32 v209, v209, v234, v236
v_fma_f32 v210, v210, v234, v236
v_fma_f32 v211, v211, v234, v236
v_fma_f32 v212, v212, v234, v236
v_fma_f32 v213, v213, v234, v236
v_fma_f32 v214, v214, v234, v236
v_fma_f32 v215, v215, v234, v236
v_mfma_f32_32x32x16_bf16 v[160:175], v[68:71], v[196:199], v[160:175]
v_cvt_pk_bf16_f32 v76, v208, v209
v_cvt_pk_bf16_f32 v77, v210, v211
v_cvt_pk_bf16_f32 v78, v212, v213
v_cvt_pk_bf16_f32 v79, v214, v215
ds_read_b64_tr_b16 v[188:189], v2 offset:36864
ds_read_b64_tr_b16 v[190:191], v2 offset:37376
ds_read_b64_tr_b16 v[192:193], v2 offset:38912
ds_read_b64_tr_b16 v[194:195], v2 offset:39424
ds_read_b64_tr_b16 v[196:197], v2 offset:40960
ds_read_b64_tr_b16 v[198:199], v2 offset:41472
s_waitcnt lgkmcnt(6)
v_mfma_f32_32x32x16_bf16 v[128:143], v[176:179], v[72:75], v[128:143]
v_lshlrev_b32 v200, 16, v80
v_and_b32 v201, 0xffff0000, v80
v_lshlrev_b32 v202, 16, v81
v_and_b32 v203, 0xffff0000, v81
v_lshlrev_b32 v204, 16, v82
v_and_b32 v205, 0xffff0000, v82
v_lshlrev_b32 v206, 16, v83
v_and_b32 v207, 0xffff0000, v83
v_mfma_f32_32x32x16_bf16 v[144:159], v[180:183], v[72:75], v[144:159]
v_fma_f32 v200, v200, v234, v236
v_fma_f32 v201, v201, v234, v236
v_fma_f32 v202, v202, v234, v236
v_fma_f32 v203, v203, v234, v236
v_fma_f32 v204, v204, v234, v236
v_fma_f32 v205, v205, v234, v236
v_fma_f32 v206, v206, v234, v236
v_fma_f32 v207, v207, v234, v236
v_mfma_f32_32x32x16_bf16 v[160:175], v[72:75], v[184:187], v[160:175]
v_cvt_pk_bf16_f32 v80, v200, v201
v_cvt_pk_bf16_f32 v81, v202, v203
v_cvt_pk_bf16_f32 v82, v204, v205
v_cvt_pk_bf16_f32 v83, v206, v207
s_waitcnt lgkmcnt(0)
v_mfma_f32_32x32x16_bf16 v[128:143], v[188:191], v[76:79], v[128:143]
v_lshlrev_b32 v208, 16, v84
v_and_b32 v209, 0xffff0000, v84
v_lshlrev_b32 v210, 16, v85
v_and_b32 v211, 0xffff0000, v85
v_lshlrev_b32 v212, 16, v86
v_and_b32 v213, 0xffff0000, v86
v_lshlrev_b32 v214, 16, v87
v_and_b32 v215, 0xffff0000, v87
v_mfma_f32_32x32x16_bf16 v[144:159], v[192:195], v[76:79], v[144:159]
v_fma_f32 v208, v208, v234, v236
v_fma_f32 v209, v209, v234, v236
v_fma_f32 v210, v210, v234, v236
v_fma_f32 v211, v211, v234, v236
v_fma_f32 v212, v212, v234, v236
v_fma_f32 v213, v213, v234, v236
v_fma_f32 v214, v214, v234, v236
v_fma_f32 v215, v215, v234, v236
v_mfma_f32_32x32x16_bf16 v[160:175], v[76:79], v[196:199], v[160:175]
v_cvt_pk_bf16_f32 v84, v208, v209
v_cvt_pk_bf16_f32 v85, v210, v211
v_cvt_pk_bf16_f32 v86, v212, v213
v_cvt_pk_bf16_f32 v87, v214, v215
s_cmp_ge_u32 s5, 4
s_cbranch_scc1 L_gb_4
s_add_u32 m0, s52, 98304
s_add_u32 s31, s53, 393216
buffer_load_dwordx4 v21, s[12:15], s31 offen lds
s_add_u32 m0, s52, 99328
s_add_u32 s31, s53, 417792
buffer_load_dwordx4 v21, s[12:15], s31 offen lds
s_add_u32 m0, s52, 100352
s_add_u32 s31, s53, 394240
buffer_load_dwordx4 v21, s[12:15], s31 offen lds
s_add_u32 m0, s52, 101376
s_add_u32 s31, s53, 418816
buffer_load_dwordx4 v21, s[12:15], s31 offen lds
s_add_u32 m0, s52, 102400
s_add_u32 s31, s53, 395264
buffer_load_dwordx4 v21, s[12:15], s31 offen lds
s_add_u32 m0, s52, 103424
s_add_u32 s31, s53, 419840
buffer_load_dwordx4 v21, s[12:15], s31 offen lds
s_add_u32 m0, s52, 104448
s_add_u32 s31, s53, 1179648
buffer_load_dwordx4 v21, s[12:15], s31 offen lds
s_add_u32 m0, s52, 105472
s_add_u32 s31, s53, 1204224
buffer_load_dwordx4 v21, s[12:15], s31 offen lds
s_add_u32 m0, s52, 106496
s_add_u32 s31, s53, 1180672
buffer_load_dwordx4 v21, s[12:15], s31 offen lds
s_add_u32 m0, s52, 107520
s_add_u32 s31, s53, 1205248
buffer_load_dwordx4 v21, s[12:15], s31 offen lds
s_add_u32 m0, s52, 108544
s_add_u32 s31, s53, 1181696
buffer_load_dwordx4 v21, s[12:15], s31 offen lds
s_add_u32 m0, s52, 109568
s_add_u32 s31, s53, 1206272
buffer_load_dwordx4 v21, s[12:15], s31 offen lds
L_gb_4:
s_getpc_b64 s[38:39]
L_pcref:
s_and_b32 s38, s38, 0xffffff00
s_lshl_b32 s36, s5, 12
v_lshlrev_b32 v5, 7, v1
v_add_u32 v5, s36, v5
v_min_u32 v5, 0x5880, v5
s_mov_b64 exec, 0xffffffff
global_load_dword v252, v5, s[38:39]
s_mov_b64 exec, -1
s_cmp_lt_u32 s5, 4
s_cbranch_scc1 L_wa_5
s_waitcnt vmcnt(1)
s_branch L_wb_6
L_wa_5:
L_wb_6:
s_barrier
s_cmp_lt_u32 s5, 4
s_cbranch_scc1 L_gb_7
s_add_u32 m0, s52, 0
s_add_u32 s31, s53, 589824
buffer_load_dwordx4 v21, s[12:15], s31 offen lds
s_add_u32 m0, s52, 1024
s_add_u32 s31, s53, 614400
buffer_load_dwordx4 v21, s[12:15], s31 offen lds
s_add_u32 m0, s52, 2048
s_add_u32 s31, s53, 590848
buffer_load_dwordx4 v21, s[12:15], s31 offen lds
s_add_u32 m0, s52, 3072
s_add_u32 s31, s53, 615424
buffer_load_dwordx4 v21, s[12:15], s31 offen lds
s_add_u32 m0, s52, 4096
s_add_u32 s31, s53, 591872
buffer_load_dwordx4 v21, s[12:15], s31 offen lds
s_add_u32 m0, s52, 5120
s_add_u32 s31, s53, 616448
buffer_load_dwordx4 v21, s[12:15], s31 offen lds
s_add_u32 m0, s52, 6144
s_add_u32 s31, s53, 1376256
buffer_load_dwordx4 v21, s[12:15], s31 offen lds
s_add_u32 m0, s52, 7168
s_add_u32 s31, s53, 1400832
buffer_load_dwordx4 v21, s[12:15], s31 offen lds
s_add_u32 m0, s52, 8192
s_add_u32 s31, s53, 1377280
buffer_load_dwordx4 v21, s[12:15], s31 offen lds
s_add_u32 m0, s52, 9216
s_add_u32 s31, s53, 1401856
buffer_load_dwordx4 v21, s[12:15], s31 offen lds
s_add_u32 m0, s52, 10240
s_add_u32 s31, s53, 1378304
buffer_load_dwordx4 v21, s[12:15], s31 offen lds
s_add_u32 m0, s52, 11264
s_add_u32 s31, s53, 1402880
buffer_load_dwordx4 v21, s[12:15], s31 offen lds
L_gb_7:
ds_read_b64_tr_b16 v[176:177], v3 offset:0
ds_read_b64_tr_b16 v[178:179], v3 offset:512
ds_read_b64_tr_b16 v[180:181], v3 offset:2048
ds_read_b64_tr_b16 v[182:183], v3 offset:2560
ds_read_b64_tr_b16 v[184:185], v3 offset:4096
ds_read_b64_tr_b16 v[186:187], v3 offset:4608
ds_read_b64_tr_b16 v[188:189], v3 offset:12288
ds_read_b64_tr_b16 v[190:191], v3 offset:12800
ds_read_b64_tr_b16 v[192:193], v3 offset:14336
ds_read_b64_tr_b16 v[194:195], v3 offset:14848
ds_read_b64_tr_b16 v[196:197], v3 offset:16384
ds_read_b64_tr_b16 v[198:199], v3 offset:16896
s_waitcnt lgkmcnt(6)
v_mfma_f32_32x32x16_bf16 v[128:143], v[176:179], v[80:83], v[128:143]
v_lshlrev_b32 v200, 16, v88
v_and_b32 v201, 0xffff0000, v88
v_lshlrev_b32 v202, 16, v89
v_and_b32 v203, 0xffff0000, v89
v_lshlrev_b32 v204, 16, v90
v_and_b32 v205, 0xffff0000, v90
v_lshlrev_b32 v206, 16, v91
v_and_b32 v207, 0xffff0000, v91
v_mfma_f32_32x32x16_bf16 v[144:159], v[180:183], v[80:83], v[144:159]
v_fma_f32 v200, v200, v234, v236
v_fma_f32 v201, v201, v234, v236
v_fma_f32 v202, v202, v234, v236
v_fma_f32 v203, v203, v234, v236
v_fma_f32 v204, v204, v234, v236
v_fma_f32 v205, v205, v234, v236
v_fma_f32 v206, v206, v234, v236
v_fma_f32 v207, v207, v234, v236
v_mfma_f32_32x32x16_bf16 v[160:175], v[80:83], v[184:187], v[160:175]
v_cvt_pk_bf16_f32 v88, v200, v201
v_cvt_pk_bf16_f32 v89, v202, v203
v_cvt_pk_bf16_f32 v90, v204, v205
v_cvt_pk_bf16_f32 v91, v206, v207
ds_read_b64_tr_b16 v[176:177], v3 offset:24576
ds_read_b64_tr_b16 v[178:179], v3 offset:25088
ds_read_b64_tr_b16 v[180:181], v3 offset:26624
ds_read_b64_tr_b16 v[182:183], v3 offset:27136
ds_read_b64_tr_b16 v[184:185], v3 offset:28672
ds_read_b64_tr_b16 v[186:187], v3 offset:29184
s_waitcnt lgkmcnt(6)
v_mfma_f32_32x32x16_bf16 v[128:143], v[188:191], v[84:87], v[128:143]
v_lshlrev_b32 v208, 16, v92
v_and_b32 v209, 0xffff0000, v92
v_lshlrev_b32 v210, 16, v93
v_and_b32 v211, 0xffff0000, v93
v_lshlrev_b32 v212, 16, v94
v_and_b32 v213, 0xffff0000, v94
v_lshlrev_b32 v214, 16, v95
v_and_b32 v215, 0xffff0000, v95
v_mfma_f32_32x32x16_bf16 v[144:159], v[192:195], v[84:87], v[144:159]
v_fma_f32 v208, v208, v234, v236
v_fma_f32 v209, v209, v234, v236
v_fma_f32 v210, v210, v234, v236
v_fma_f32 v211, v211, v234, v236
v_fma_f32 v212, v212, v234, v236
v_fma_f32 v213, v213, v234, v236
v_fma_f32 v214, v214, v234, v236
v_fma_f32 v215, v215, v234, v236
v_mfma_f32_32x32x16_bf16 v[160:175], v[84:87], v[196:199], v[160:175]
v_cvt_pk_bf16_f32 v92, v208, v209
v_cvt_pk_bf16_f32 v93, v210, v211
v_cvt_pk_bf16_f32 v94, v212, v213
v_cvt_pk_bf16_f32 v95, v214, v215
ds_read_b64_tr_b16 v[188:189], v3 offset:36864
ds_read_b64_tr_b16 v[190:191], v3 offset:37376
ds_read_b64_tr_b16 v[192:193], v3 offset:38912
ds_read_b64_tr_b16 v[194:195], v3 offset:39424
ds_read_b64_tr_b16 v[196:197], v3 offset:40960
ds_read_b64_tr_b16 v[198:199], v3 offset:41472
s_waitcnt lgkmcnt(6)
v_mfma_f32_32x32x16_bf16 v[128:143], v[176:179], v[88:91], v[128:143]
v_lshlrev_b32 v200, 16, v96
v_and_b32 v201, 0xffff0000, v96
v_lshlrev_b32 v202, 16, v97
v_and_b32 v203, 0xffff0000, v97
v_lshlrev_b32 v204, 16, v98
v_and_b32 v205, 0xffff0000, v98
v_lshlrev_b32 v206, 16, v99
v_and_b32 v207, 0xffff0000, v99
v_mfma_f32_32x32x16_bf16 v[144:159], v[180:183], v[88:91], v[144:159]
v_fma_f32 v200, v200, v234, v236
v_fma_f32 v201, v201, v234, v236
v_fma_f32 v202, v202, v234, v236
v_fma_f32 v203, v203, v234, v236
v_fma_f32 v204, v204, v234, v236
v_fma_f32 v205, v205, v234, v236
v_fma_f32 v206, v206, v234, v236
v_fma_f32 v207, v207, v234, v236
v_mfma_f32_32x32x16_bf16 v[160:175], v[88:91], v[184:187], v[160:175]
v_cvt_pk_bf16_f32 v96, v200, v201
v_cvt_pk_bf16_f32 v97, v202, v203
v_cvt_pk_bf16_f32 v98, v204, v205
v_cvt_pk_bf16_f32 v99, v206, v207
s_waitcnt lgkmcnt(0)
v_mfma_f32_32x32x16_bf16 v[128:143], v[188:191], v[92:95], v[128:143]
v_lshlrev_b32 v208, 16, v100
v_and_b32 v209, 0xffff0000, v100
v_lshlrev_b32 v210, 16, v101
v_and_b32 v211, 0xffff0000, v101
v_lshlrev_b32 v212, 16, v102
v_and_b32 v213, 0xffff0000, v102
v_lshlrev_b32 v214, 16, v103
v_and_b32 v215, 0xffff0000, v103
v_mfma_f32_32x32x16_bf16 v[144:159], v[192:195], v[92:95], v[144:159]
v_fma_f32 v208, v208, v234, v236
v_fma_f32 v209, v209, v234, v236
v_fma_f32 v210, v210, v234, v236
v_fma_f32 v211, v211, v234, v236
v_fma_f32 v212, v212, v234, v236
v_fma_f32 v213, v213, v234, v236
v_fma_f32 v214, v214, v234, v236
v_fma_f32 v215, v215, v234, v236
v_mfma_f32_32x32x16_bf16 v[160:175], v[92:95], v[196:199], v[160:175]
v_cvt_pk_bf16_f32 v100, v208, v209
v_cvt_pk_bf16_f32 v101, v210, v211
v_cvt_pk_bf16_f32 v102, v212, v213
v_cvt_pk_bf16_f32 v103, v214, v215
s_mov_b32 s20, s68
s_mov_b32 s21, s69
s_mov_b32 s22, 524288
s_mov_b32 s23, 0x20000
s_and_b32 s6, s3, 3
s_lshl_b32 s6, s6, 3
s_add_u32 s6, s6, s4
s_lshl_b32 s6, s6, 3
s_add_u32 s6, s6, s5
s_mul_i32 s6, s6, 2048
v_lshlrev_b32 v5, 7, v1
s_mov_b64 exec, 0xffff
buffer_load_dword v252, v5, s[20:23], s6 offen
s_mov_b64 exec, -1
s_mov_b32 s16, s72
s_mov_b32 s17, s73
s_mov_b32 s18, 1409024
s_mov_b32 s19, 0x20000
s_and_b32 s6, s3, 3
s_lshl_b32 s6, s6, 3
s_add_u32 s6, s6, s4
s_lshl_b32 s6, s6, 3
s_add_u32 s6, s6, s5
s_mul_i32 s6, s6, 5504
v_lshlrev_b32 v5, 7, v1
s_mov_b32 exec_hi, 0x7ff
buffer_load_dword v252, v5, s[16:19], s6 offen
s_mov_b64 exec, -1
s_cmp_lt_u32 s5, 4
s_cbranch_scc1 L_wa_8
s_branch L_wb_9
L_wa_8:
s_waitcnt vmcnt(3)
L_wb_9:
s_barrier
ds_read_b64_tr_b16 v[176:177], v4 offset:0
ds_read_b64_tr_b16 v[178:179], v4 offset:512
ds_read_b64_tr_b16 v[180:181], v4 offset:2048
ds_read_b64_tr_b16 v[182:183], v4 offset:2560
ds_read_b64_tr_b16 v[184:185], v4 offset:4096
ds_read_b64_tr_b16 v[186:187], v4 offset:4608
ds_read_b64_tr_b16 v[188:189], v4 offset:12288
ds_read_b64_tr_b16 v[190:191], v4 offset:12800
ds_read_b64_tr_b16 v[192:193], v4 offset:14336
ds_read_b64_tr_b16 v[194:195], v4 offset:14848
ds_read_b64_tr_b16 v[196:197], v4 offset:16384
ds_read_b64_tr_b16 v[198:199], v4 offset:16896
s_waitcnt lgkmcnt(6)
v_mfma_f32_32x32x16_bf16 v[128:143], v[176:179], v[96:99], v[128:143]
v_lshlrev_b32 v200, 16, v104
v_and_b32 v201, 0xffff0000, v104
v_lshlrev_b32 v202, 16, v105
v_and_b32 v203, 0xffff0000, v105
v_lshlrev_b32 v204, 16, v106
v_and_b32 v205, 0xffff0000, v106
v_lshlrev_b32 v206, 16, v107
v_and_b32 v207, 0xffff0000, v107
v_mfma_f32_32x32x16_bf16 v[144:159], v[180:183], v[96:99], v[144:159]
v_fma_f32 v200, v200, v234, v236
v_fma_f32 v201, v201, v234, v236
v_fma_f32 v202, v202, v234, v236
v_fma_f32 v203, v203, v234, v236
v_fma_f32 v204, v204, v234, v236
v_fma_f32 v205, v205, v234, v236
v_fma_f32 v206, v206, v234, v236
v_fma_f32 v207, v207, v234, v236
v_mfma_f32_32x32x16_bf16 v[160:175], v[96:99], v[184:187], v[160:175]
v_cvt_pk_bf16_f32 v104, v200, v201
v_cvt_pk_bf16_f32 v105, v202, v203
v_cvt_pk_bf16_f32 v106, v204, v205
v_cvt_pk_bf16_f32 v107, v206, v207
ds_read_b64_tr_b16 v[176:177], v4 offset:24576
ds_read_b64_tr_b16 v[178:179], v4 offset:25088
ds_read_b64_tr_b16 v[180:181], v4 offset:26624
ds_read_b64_tr_b16 v[182:183], v4 offset:27136
ds_read_b64_tr_b16 v[184:185], v4 offset:28672
ds_read_b64_tr_b16 v[186:187], v4 offset:29184
s_waitcnt lgkmcnt(6)
v_mfma_f32_32x32x16_bf16 v[128:143], v[188:191], v[100:103], v[128:143]
v_lshlrev_b32 v208, 16, v108
v_and_b32 v209, 0xffff0000, v108
v_lshlrev_b32 v210, 16, v109
v_and_b32 v211, 0xffff0000, v109
v_lshlrev_b32 v212, 16, v110
v_and_b32 v213, 0xffff0000, v110
v_lshlrev_b32 v214, 16, v111
v_and_b32 v215, 0xffff0000, v111
v_mfma_f32_32x32x16_bf16 v[144:159], v[192:195], v[100:103], v[144:159]
v_fma_f32 v208, v208, v234, v236
v_fma_f32 v209, v209, v234, v236
v_fma_f32 v210, v210, v234, v236
v_fma_f32 v211, v211, v234, v236
v_fma_f32 v212, v212, v234, v236
v_fma_f32 v213, v213, v234, v236
v_fma_f32 v214, v214, v234, v236
v_fma_f32 v215, v215, v234, v236
v_mfma_f32_32x32x16_bf16 v[160:175], v[100:103], v[196:199], v[160:175]
v_cvt_pk_bf16_f32 v108, v208, v209
v_cvt_pk_bf16_f32 v109, v210, v211
v_cvt_pk_bf16_f32 v110, v212, v213
v_cvt_pk_bf16_f32 v111, v214, v215
ds_read_b64_tr_b16 v[188:189], v4 offset:36864
ds_read_b64_tr_b16 v[190:191], v4 offset:37376
ds_read_b64_tr_b16 v[192:193], v4 offset:38912
ds_read_b64_tr_b16 v[194:195], v4 offset:39424
ds_read_b64_tr_b16 v[196:197], v4 offset:40960
ds_read_b64_tr_b16 v[198:199], v4 offset:41472
s_waitcnt lgkmcnt(6)
v_mfma_f32_32x32x16_bf16 v[128:143], v[176:179], v[104:107], v[128:143]
v_lshlrev_b32 v200, 16, v112
v_and_b32 v201, 0xffff0000, v112
v_lshlrev_b32 v202, 16, v113
v_and_b32 v203, 0xffff0000, v113
v_lshlrev_b32 v204, 16, v114
v_and_b32 v205, 0xffff0000, v114
v_lshlrev_b32 v206, 16, v115
v_and_b32 v207, 0xffff0000, v115
v_mfma_f32_32x32x16_bf16 v[144:159], v[180:183], v[104:107], v[144:159]
v_fma_f32 v200, v200, v234, v236
v_fma_f32 v201, v201, v234, v236
v_fma_f32 v202, v202, v234, v236
v_fma_f32 v203, v203, v234, v236
v_fma_f32 v204, v204, v234, v236
v_fma_f32 v205, v205, v234, v236
v_fma_f32 v206, v206, v234, v236
v_fma_f32 v207, v207, v234, v236
v_mfma_f32_32x32x16_bf16 v[160:175], v[104:107], v[184:187], v[160:175]
v_cvt_pk_bf16_f32 v112, v200, v201
v_cvt_pk_bf16_f32 v113, v202, v203
v_cvt_pk_bf16_f32 v114, v204, v205
v_cvt_pk_bf16_f32 v115, v206, v207
s_waitcnt lgkmcnt(0)
v_mfma_f32_32x32x16_bf16 v[128:143], v[188:191], v[108:111], v[128:143]
v_lshlrev_b32 v208, 16, v116
v_and_b32 v209, 0xffff0000, v116
v_lshlrev_b32 v210, 16, v117
v_and_b32 v211, 0xffff0000, v117
v_lshlrev_b32 v212, 16, v118
v_and_b32 v213, 0xffff0000, v118
v_lshlrev_b32 v214, 16, v119
v_and_b32 v215, 0xffff0000, v119
v_mfma_f32_32x32x16_bf16 v[144:159], v[192:195], v[108:111], v[144:159]
v_fma_f32 v208, v208, v234, v236
v_fma_f32 v209, v209, v234, v236
v_fma_f32 v210, v210, v234, v236
v_fma_f32 v211, v211, v234, v236
v_fma_f32 v212, v212, v234, v236
v_fma_f32 v213, v213, v234, v236
v_fma_f32 v214, v214, v234, v236
v_fma_f32 v215, v215, v234, v236
v_mfma_f32_32x32x16_bf16 v[160:175], v[108:111], v[196:199], v[160:175]
v_cvt_pk_bf16_f32 v116, v208, v209
v_cvt_pk_bf16_f32 v117, v210, v211
v_cvt_pk_bf16_f32 v118, v212, v213
v_cvt_pk_bf16_f32 v119, v214, v215
s_cmp_lt_u32 s5, 4
s_cbranch_scc1 L_wa_10
s_waitcnt vmcnt(2)
s_branch L_wb_11
L_wa_10:
L_wb_11:
s_barrier
ds_read_b64_tr_b16 v[176:177], v2 offset:0
ds_read_b64_tr_b16 v[178:179], v2 offset:512
ds_read_b64_tr_b16 v[180:181], v2 offset:2048
ds_read_b64_tr_b16 v[182:183], v2 offset:2560
ds_read_b64_tr_b16 v[184:185], v2 offset:4096
ds_read_b64_tr_b16 v[186:187], v2 offset:4608
ds_read_b64_tr_b16 v[188:189], v2 offset:12288
ds_read_b64_tr_b16 v[190:191], v2 offset:12800
ds_read_b64_tr_b16 v[192:193], v2 offset:14336
ds_read_b64_tr_b16 v[194:195], v2 offset:14848
ds_read_b64_tr_b16 v[196:197], v2 offset:16384
ds_read_b64_tr_b16 v[198:199], v2 offset:16896
s_waitcnt lgkmcnt(6)
v_mfma_f32_32x32x16_bf16 v[128:143], v[176:179], v[112:115], v[128:143]
v_lshlrev_b32 v200, 16, v120
v_and_b32 v201, 0xffff0000, v120
v_lshlrev_b32 v202, 16, v121
v_and_b32 v203, 0xffff0000, v121
v_lshlrev_b32 v204, 16, v122
v_and_b32 v205, 0xffff0000, v122
v_lshlrev_b32 v206, 16, v123
v_and_b32 v207, 0xffff0000, v123
v_mfma_f32_32x32x16_bf16 v[144:159], v[180:183], v[112:115], v[144:159]
v_fma_f32 v200, v200, v234, v236
v_fma_f32 v201, v201, v234, v236
v_fma_f32 v202, v202, v234, v236
v_fma_f32 v203, v203, v234, v236
v_fma_f32 v204, v204, v234, v236
v_fma_f32 v205, v205, v234, v236
v_fma_f32 v206, v206, v234, v236
v_fma_f32 v207, v207, v234, v236
v_mfma_f32_32x32x16_bf16 v[160:175], v[112:115], v[184:187], v[160:175]
v_cvt_pk_bf16_f32 v120, v200, v201
v_cvt_pk_bf16_f32 v121, v202, v203
v_cvt_pk_bf16_f32 v122, v204, v205
v_cvt_pk_bf16_f32 v123, v206, v207
ds_read_b64_tr_b16 v[176:177], v2 offset:24576
ds_read_b64_tr_b16 v[178:179], v2 offset:25088
ds_read_b64_tr_b16 v[180:181], v2 offset:26624
ds_read_b64_tr_b16 v[182:183], v2 offset:27136
ds_read_b64_tr_b16 v[184:185], v2 offset:28672
ds_read_b64_tr_b16 v[186:187], v2 offset:29184
s_waitcnt lgkmcnt(6)
v_mfma_f32_32x32x16_bf16 v[128:143], v[188:191], v[116:119], v[128:143]
v_lshlrev_b32 v208, 16, v124
v_and_b32 v209, 0xffff0000, v124
v_lshlrev_b32 v210, 16, v125
v_and_b32 v211, 0xffff0000, v125
v_lshlrev_b32 v212, 16, v126
v_and_b32 v213, 0xffff0000, v126
v_lshlrev_b32 v214, 16, v127
v_and_b32 v215, 0xffff0000, v127
v_mfma_f32_32x32x16_bf16 v[144:159], v[192:195], v[116:119], v[144:159]
v_fma_f32 v208, v208, v234, v236
v_fma_f32 v209, v209, v234, v236
v_fma_f32 v210, v210, v234, v236
v_fma_f32 v211, v211, v234, v236
v_fma_f32 v212, v212, v234, v236
v_fma_f32 v213, v213, v234, v236
v_fma_f32 v214, v214, v234, v236
v_fma_f32 v215, v215, v234, v236
v_mfma_f32_32x32x16_bf16 v[160:175], v[116:119], v[196:199], v[160:175]
v_cvt_pk_bf16_f32 v124, v208, v209
v_cvt_pk_bf16_f32 v125, v210, v211
v_cvt_pk_bf16_f32 v126, v212, v213
v_cvt_pk_bf16_f32 v127, v214, v215
ds_read_b64_tr_b16 v[188:189], v2 offset:36864
ds_read_b64_tr_b16 v[190:191], v2 offset:37376
ds_read_b64_tr_b16 v[192:193], v2 offset:38912
ds_read_b64_tr_b16 v[194:195], v2 offset:39424
ds_read_b64_tr_b16 v[196:197], v2 offset:40960
ds_read_b64_tr_b16 v[198:199], v2 offset:41472
s_waitcnt lgkmcnt(6)
v_mfma_f32_32x32x16_bf16 v[128:143], v[176:179], v[120:123], v[128:143]
v_mfma_f32_32x32x16_bf16 v[144:159], v[180:183], v[120:123], v[144:159]
v_mfma_f32_32x32x16_bf16 v[160:175], v[120:123], v[184:187], v[160:175]
s_waitcnt lgkmcnt(0)
v_mfma_f32_32x32x16_bf16 v[128:143], v[188:191], v[124:127], v[128:143]
v_mfma_f32_32x32x16_bf16 v[144:159], v[192:195], v[124:127], v[144:159]
v_mfma_f32_32x32x16_bf16 v[160:175], v[124:127], v[196:199], v[160:175]
v_lshlrev_b32 v5, 4, v1
s_mul_i32 s38, s5, 6144
s_add_u32 s38, s38, 0
v_add_u32 v6, s38, v5
s_xor_b32 s38, s5, 4
s_mul_i32 s38, s38, 6144
s_add_u32 s38, s38, 0
v_add_u32 v7, s38, v5
s_lshl_b32 s40, s3, 1
s_add_u32 s40, s40, s26
s_lshl_b32 s40, s40, 5
s_lshl_b32 s41, s4, 2
s_add_u32 s40, s40, s41
s_lshl_b32 s41, s28, 1
s_add_u32 s40, s40, s41
s_add_u32 s41, s40, s27
s_lshl_b32 s41, s41, 10
s_add_u32 s41, s41, 2097152
s_lshl_b32 s40, s40, 10
s_lshl_b32 s42, s27, 9
s_add_u32 s40, s40, s42
s_add_u32 s40, s40, 4194304
v_lshrrev_b32 v12, 5, v1
v_bfe_u32 v15, v1, 4, 1
v_lshlrev_b32 v15, 10, v15
v_lshlrev_b32 v11, 8, v12
v_add_u32 v15, v15, v11
v_and_b32 v11, 15, v1
v_lshlrev_b32 v11, 4, v11
v_add_u32 v15, v15, v11
s_barrier
s_nop 7
s_cmp_eq_u32 s27, 1
s_cbranch_scc1 L_k1_12
ds_write_b128 v6, v[152:155] offset:2048
ds_write_b128 v6, v[156:159] offset:3072
ds_write_b128 v6, v[168:171] offset:4096
ds_write_b128 v6, v[172:175] offset:5120
ds_write_b128 v6, v[136:139] offset:0
ds_write_b128 v6, v[140:143] offset:1024
s_branch L_j_13
L_k1_12:
ds_write_b128 v6, v[144:147] offset:2048
ds_write_b128 v6, v[148:151] offset:3072
ds_write_b128 v6, v[160:163] offset:4096
ds_write_b128 v6, v[164:167] offset:5120
ds_write_b128 v6, v[128:131] offset:0
ds_write_b128 v6, v[132:135] offset:1024
L_j_13:
s_waitcnt lgkmcnt(0)
s_barrier
ds_read_b128 v[208:211], v7 offset:2048
ds_read_b128 v[212:215], v7 offset:3072
ds_read_b128 v[216:219], v7 offset:4096
ds_read_b128 v[220:223], v7 offset:5120
ds_read_b128 v[200:203], v7 offset:0
ds_read_b128 v[204:207], v7 offset:1024
s_cmp_eq_u32 s27, 1
s_cbranch_scc1 L_k1_14
s_waitcnt lgkmcnt(4)
v_add_f32 v208, v208, v144
v_add_f32 v209, v209, v145
v_add_f32 v210, v210, v146
v_add_f32 v211, v211, v147
v_add_f32 v212, v212, v148
v_add_f32 v213, v213, v149
v_add_f32 v214, v214, v150
v_add_f32 v215, v215, v151
v_cvt_pk_bf16_f32 v96, v208, v209
v_cvt_pk_bf16_f32 v97, v210, v211
v_cvt_pk_bf16_f32 v98, v212, v213
v_cvt_pk_bf16_f32 v99, v214, v215
buffer_store_dwordx4 v[96:99], v5, s[8:11], s41 offen sc1
s_waitcnt lgkmcnt(2)
v_add_f32 v216, v216, v160
v_add_f32 v217, v217, v161
v_add_f32 v218, v218, v162
v_add_f32 v219, v219, v163
v_add_f32 v220, v220, v164
v_add_f32 v221, v221, v165
v_add_f32 v222, v222, v166
v_add_f32 v223, v223, v167
v_cvt_pk_bf16_f32 v100, v216, v217
v_cvt_pk_bf16_f32 v101, v218, v219
v_cvt_pk_bf16_f32 v102, v220, v221
v_cvt_pk_bf16_f32 v103, v222, v223
buffer_store_dwordx4 v[100:103], v15, s[8:11], s40 offen sc1
s_waitcnt lgkmcnt(0)
v_add_f32 v200, v200, v128
v_add_f32 v201, v201, v129
v_add_f32 v202, v202, v130
v_add_f32 v203, v203, v131
v_add_f32 v204, v204, v132
v_add_f32 v205, v205, v133
v_add_f32 v206, v206, v134
v_add_f32 v207, v207, v135
s_branch L_j_15
L_k1_14:
s_waitcnt lgkmcnt(4)
v_add_f32 v208, v208, v152
v_add_f32 v209, v209, v153
v_add_f32 v210, v210, v154
v_add_f32 v211, v211, v155
v_add_f32 v212, v212, v156
v_add_f32 v213, v213, v157
v_add_f32 v214, v214, v158
v_add_f32 v215, v215, v159
v_cvt_pk_bf16_f32 v96, v208, v209
v_cvt_pk_bf16_f32 v97, v210, v211
v_cvt_pk_bf16_f32 v98, v212, v213
v_cvt_pk_bf16_f32 v99, v214, v215
buffer_store_dwordx4 v[96:99], v5, s[8:11], s41 offen sc1
s_waitcnt lgkmcnt(2)
v_add_f32 v216, v216, v168
v_add_f32 v217, v217, v169
v_add_f32 v218, v218, v170
v_add_f32 v219, v219, v171
v_add_f32 v220, v220, v172
v_add_f32 v221, v221, v173
v_add_f32 v222, v222, v174
v_add_f32 v223, v223, v175
v_cvt_pk_bf16_f32 v100, v216, v217
v_cvt_pk_bf16_f32 v101, v218, v219
v_cvt_pk_bf16_f32 v102, v220, v221
v_cvt_pk_bf16_f32 v103, v222, v223
buffer_store_dwordx4 v[100:103], v15, s[8:11], s40 offen sc1
s_waitcnt lgkmcnt(0)
v_add_f32 v200, v200, v136
v_add_f32 v201, v201, v137
v_add_f32 v202, v202, v138
v_add_f32 v203, v203, v139
v_add_f32 v204, v204, v140
v_add_f32 v205, v205, v141
v_add_f32 v206, v206, v142
v_add_f32 v207, v207, v143
L_j_15:
v_mul_f32 v200, 0x3eb8aa3b, v200
v_mul_f32 v201, 0x3eb8aa3b, v201
v_mul_f32 v202, 0x3eb8aa3b, v202
v_mul_f32 v203, 0x3eb8aa3b, v203
v_mul_f32 v204, 0x3eb8aa3b, v204
v_mul_f32 v205, 0x3eb8aa3b, v205
v_mul_f32 v206, 0x3eb8aa3b, v206
v_mul_f32 v207, 0x3eb8aa3b, v207
v_cvt_pk_bf16_f32 v244, v200, v201
v_cvt_pk_bf16_f32 v245, v202, v203
v_cvt_pk_bf16_f32 v246, v204, v205
v_cvt_pk_bf16_f32 v247, v206, v207
s_waitcnt vmcnt(0)
s_barrier
s_cmp_lg_u32 s5, 0
s_cbranch_scc1 L_nf_16
s_lshl_b32 s62, s4, 7
s_lshl_b32 s6, s3, 2
s_add_u32 s62, s62, s6
s_add_u32 s62, s62, 16777216
s_mov_b64 exec, 1
v_mov_b32 v254, s60
buffer_store_dword v254, off, s[8:11], s62 sc1
s_mov_b64 exec, -1
L_nf_16:
s_and_b32 s26, s5, 1
s_lshl_b32 s28, s3, 1
s_add_u32 s28, s28, s26
s_bfe_u32 s27, s5, 0x10001
s_lshl_b32 s27, s27, 1
s_lshr_b32 s29, s5, 2
s_add_u32 s29, s29, s27
s_lshl_b32 s27, s4, 2
s_add_u32 s29, s29, s27
s_sub_i32 s30, 8, s28
s_max_i32 s30, s30, 0
v_lshlrev_b32 v236, 4, v1
s_lshl_b32 s31, s28, 5
s_add_u32 s31, s31, s29
s_lshl_b32 s31, s31, 10
v_lshrrev_b32 v237, 5, v1
v_lshlrev_b32 v237, 8, v237
v_and_b32 v238, 15, v1
v_lshlrev_b32 v238, 4, v238
v_add_u32 v237, v237, v238
v_mov_b32 v44, 0x3f803f80
v_mov_b32 v45, 0x3f803f80
v_mov_b32 v46, 0x3f803f80
v_mov_b32 v47, 0x3f803f80
v_mov_b32 v48, 0x3f803f80
v_mov_b32 v49, 0x3f803f80
v_mov_b32 v50, 0x3f803f80
v_mov_b32 v51, 0x3f803f80
v_mov_b32 v52, 0x3f803f80
v_mov_b32 v53, 0x3f803f80
v_mov_b32 v54, 0x3f803f80
v_mov_b32 v55, 0x3f803f80
v_mov_b32 v56, 0x3f803f80
v_mov_b32 v57, 0x3f803f80
v_mov_b32 v58, 0x3f803f80
v_mov_b32 v59, 0x3f803f80
v_mov_b32 v60, 0x3f803f80
v_mov_b32 v61, 0x3f803f80
v_mov_b32 v62, 0x3f803f80
v_mov_b32 v63, 0x3f803f80
v_mov_b32 v64, 0x3f803f80
v_mov_b32 v65, 0x3f803f80
v_mov_b32 v66, 0x3f803f80
v_mov_b32 v67, 0x3f803f80
v_mov_b32 v68, 0x3f803f80
v_mov_b32 v69, 0x3f803f80
v_mov_b32 v70, 0x3f803f80
v_mov_b32 v71, 0x3f803f80
v_mov_b32 v72, 0x3f803f80
v_mov_b32 v73, 0x3f803f80
v_mov_b32 v74, 0x3f803f80
v_mov_b32 v75, 0x3f803f80
v_mov_b32 v76, 0x3f803f80
v_mov_b32 v77, 0x3f803f80
v_mov_b32 v78, 0x3f803f80
v_mov_b32 v79, 0x3f803f80
v_mov_b32 v80, 0x3f803f80
v_mov_b32 v81, 0x3f803f80
v_mov_b32 v82, 0x3f803f80
v_mov_b32 v83, 0x3f803f80
v_mov_b32 v84, 0x3f803f80
v_mov_b32 v85, 0x3f803f80
v_mov_b32 v86, 0x3f803f80
v_mov_b32 v87, 0x3f803f80
v_mov_b32 v88, 0x3f803f80
v_mov_b32 v89, 0x3f803f80
v_mov_b32 v90, 0x3f803f80
v_mov_b32 v91, 0x3f803f80
v_mov_b32 v92, 0x3f803f80
v_mov_b32 v93, 0x3f803f80
v_mov_b32 v94, 0x3f803f80
v_mov_b32 v95, 0x3f803f80
v_mov_b32 v96, 0x3f803f80
v_mov_b32 v97, 0x3f803f80
v_mov_b32 v98, 0x3f803f80
v_mov_b32 v99, 0x3f803f80
v_mov_b32 v100, 0x3f803f80
v_mov_b32 v101, 0x3f803f80
v_mov_b32 v102, 0x3f803f80
v_mov_b32 v103, 0x3f803f80
v_mov_b32 v104, 0x3f803f80
v_mov_b32 v105, 0x3f803f80
v_mov_b32 v106, 0x3f803f80
v_mov_b32 v107, 0x3f803f80
v_mov_b32 v108, 0x3f803f80
v_mov_b32 v109, 0x3f803f80
v_mov_b32 v110, 0x3f803f80
v_mov_b32 v111, 0x3f803f80
v_mov_b32 v112, 0x3f803f80
v_mov_b32 v113, 0x3f803f80
v_mov_b32 v114, 0x3f803f80
v_mov_b32 v115, 0x3f803f80
v_and_b32 v238, 31, v1
v_lshrrev_b32 v239, 5, v1
v_lshlrev_b32 v239, 2, v239
v_sub_u32 v238, v238, v239
v_subrev_u32 v116, 0, v238
v_ashrrev_i32 v116, 31, v116
v_not_b32 v116, v116
v_subrev_u32 v117, 1, v238
v_ashrrev_i32 v117, 31, v117
v_not_b32 v117, v117
v_subrev_u32 v118, 2, v238
v_ashrrev_i32 v118, 31, v118
v_not_b32 v118, v118
v_subrev_u32 v119, 3, v238
v_ashrrev_i32 v119, 31, v119
v_not_b32 v119, v119
v_subrev_u32 v120, 8, v238
v_ashrrev_i32 v120, 31, v120
v_not_b32 v120, v120
v_subrev_u32 v121, 9, v238
v_ashrrev_i32 v121, 31, v121
v_not_b32 v121, v121
v_subrev_u32 v122, 10, v238
v_ashrrev_i32 v122, 31, v122
v_not_b32 v122, v122
v_subrev_u32 v123, 11, v238
v_ashrrev_i32 v123, 31, v123
v_not_b32 v123, v123
v_subrev_u32 v124, 16, v238
v_ashrrev_i32 v124, 31, v124
v_not_b32 v124, v124
v_subrev_u32 v125, 17, v238
v_ashrrev_i32 v125, 31, v125
v_not_b32 v125, v125
v_subrev_u32 v126, 18, v238
v_ashrrev_i32 v126, 31, v126
v_not_b32 v126, v126
v_subrev_u32 v127, 19, v238
v_ashrrev_i32 v127, 31, v127
v_not_b32 v127, v127
v_subrev_u32 v128, 24, v238
v_ashrrev_i32 v128, 31, v128
v_not_b32 v128, v128
v_subrev_u32 v129, 25, v238
v_ashrrev_i32 v129, 31, v129
v_not_b32 v129, v129
v_subrev_u32 v130, 26, v238
v_ashrrev_i32 v130, 31, v130
v_not_b32 v130, v130
v_subrev_u32 v131, 27, v238
v_ashrrev_i32 v131, 31, v131
v_not_b32 v131, v131
v_mov_b32 v240, 0xffff
v_bfi_b32 v132, v240, v116, v117
v_bfi_b32 v133, v240, v118, v119
v_bfi_b32 v134, v240, v120, v121
v_bfi_b32 v135, v240, v122, v123
v_bfi_b32 v136, v240, v124, v125
v_bfi_b32 v137, v240, v126, v127
v_bfi_b32 v138, v240, v128, v129
v_bfi_b32 v139, v240, v130, v131
s_mov_b32 s12, s68
s_mov_b32 s13, s69
s_mov_b32 s14, 524288
s_mov_b32 s15, 0x20000
v_lshrrev_b32 v2, 3, v1
v_mul_u32_u24 v2, 1024, v2
v_bfe_u32 v140, v1, 4, 1
v_lshlrev_b32 v140, 2, v140
v_xor_b32 v140, v140, v1
v_and_b32 v140, 7, v140
v_lshlrev_b32 v140, 4, v140
v_add_u32 v2, v2, v140
s_lshr_b32 s46, s5, 1
s_lshl_b32 s44, s46, 3
s_lshl_b32 s44, s44, 14
s_and_b32 s47, s5, 1
s_lshl_b32 s45, s47, 13
s_add_u32 s44, s44, s45
s_lshl_b32 s45, s4, 7
s_add_u32 s44, s44, s45
s_lshl_b32 s45, s46, 11
s_lshl_b32 s47, s47, 10
s_add_u32 s45, s45, s47
s_lshl_b32 s33, s3, 1
s_lshr_b32 s34, s5, 2
s_add_u32 s33, s33, s34
s_and_b32 s34, s5, 3
s_lshl_b32 s35, s4, 2
s_add_u32 s34, s34, s35
s_add_i32 s35, s33, -8
s_max_i32 s35, s35, 0
s_lshl_b32 s35, s35, 5
s_add_u32 s35, s35, s34
s_lshl_b32 s35, s35, 10
s_add_u32 s88, s35, 2097152
s_add_i32 s35, s33, -6
s_max_i32 s35, s35, 0
s_lshl_b32 s35, s35, 5
s_add_u32 s35, s35, s34
s_lshl_b32 s35, s35, 10
s_add_u32 s89, s35, 2097152
s_add_i32 s35, s33, -4
s_max_i32 s35, s35, 0
s_lshl_b32 s35, s35, 5
s_add_u32 s35, s35, s34
s_lshl_b32 s35, s35, 10
s_add_u32 s90, s35, 2097152
s_add_i32 s35, s33, -2
s_max_i32 s35, s35, 0
s_lshl_b32 s35, s35, 5
s_add_u32 s35, s35, s34
s_lshl_b32 s35, s35, 10
s_add_u32 s91, s35, 2097152
s_add_i32 s35, s33, 0
s_max_i32 s35, s35, 0
s_lshl_b32 s35, s35, 5
s_add_u32 s35, s35, s34
s_lshl_b32 s35, s35, 10
s_add_u32 s92, s35, 2097152
s_lshl_b32 s93, s5, 10
s_add_u32 s93, s93, 65536
v_add_u32 v3, 2097152, v236
s_and_b32 s33, s29, 3
s_lshl_b32 s33, s33, 10
s_lshl_b32 s34, s26, 12
s_add_u32 s33, s33, s34
s_add_u32 s33, s33, 65536
v_add_u32 v4, s33, v236
s_add_u32 s33, s33, 40960
v_add_u32 v5, s33, v237
s_add_u32 m0, s45, 0
s_add_u32 s47, s44, 0
buffer_load_dwordx4 v2, s[12:15], s47 offen lds
s_add_u32 m0, s45, 8192
s_add_u32 s47, s44, 16384
buffer_load_dwordx4 v2, s[12:15], s47 offen lds
s_add_u32 m0, s45, 16384
s_add_u32 s47, s44, 32768
buffer_load_dwordx4 v2, s[12:15], s47 offen lds
s_add_u32 m0, s45, 24576
s_add_u32 s47, s44, 49152
buffer_load_dwordx4 v2, s[12:15], s47 offen lds
s_add_u32 m0, s45, 32768
s_add_u32 s47, s44, 65536
buffer_load_dwordx4 v2, s[12:15], s47 offen lds
s_add_u32 m0, s45, 40960
s_add_u32 s47, s44, 81920
buffer_load_dwordx4 v2, s[12:15], s47 offen lds
s_add_u32 m0, s45, 49152
s_add_u32 s47, s44, 98304
buffer_load_dwordx4 v2, s[12:15], s47 offen lds
s_add_u32 m0, s45, 57344
s_add_u32 s47, s44, 114688
buffer_load_dwordx4 v2, s[12:15], s47 offen lds
s_cmp_lg_u32 s5, 0
s_cbranch_scc1 L_po_17
s_lshl_b32 s62, s4, 7
s_lshl_b32 s6, s3, 2
s_add_u32 s62, s62, s6
s_add_u32 s62, s62, 16777200
v_lshlrev_b32 v253, 2, v1
s_min_u32 s6, s3, 4
s_sub_u32 s6, 4, s6
s_lshl_b32 s6, 15, s6
s_and_b32 s6, s6, 15
s_mov_b32 s7, 0
s_cmp_eq_u64 s[6:7], 0
s_cbranch_scc1 L_pd_20
s_mov_b64 exec, s[6:7]
s_mov_b32 s61, 400015
s_add_u32 s56, s84, s62
s_addc_u32 s57, s85, 0
s_bitcmp1_b32 s6, 0
s_cselect_b32 s96, -1, 0
s_bitcmp1_b32 s6, 1
s_cselect_b32 s97, -1, 0
s_bitcmp1_b32 s6, 2
s_cselect_b32 s98, -1, 0
s_bitcmp1_b32 s6, 3
s_cselect_b32 s99, -1, 0
L_pl_19:
s_load_dwordx4 s[52:55], s[56:57], 0 glc
s_waitcnt lgkmcnt(0)
s_xor_b64 s[52:53], s[52:53], s[100:101]
s_xor_b64 s[54:55], s[54:55], s[100:101]
s_and_b64 s[52:53], s[52:53], s[96:97]
s_and_b64 s[54:55], s[54:55], s[98:99]
s_or_b64 s[52:53], s[52:53], s[54:55]
s_cmp_eq_u64 s[52:53], 0
s_cbranch_scc1 L_pd_20
s_and_b32 s58, s61, 15
s_cbranch_scc1 L_pv_21
buffer_load_dword v254, v253, s[8:11], s62 offen sc1
s_waitcnt vmcnt(0)
v_cmp_ne_u32 vcc, s60, v254
s_cbranch_vccz L_pd_20
L_pv_21:
s_sub_u32 s61, s61, 1
s_cbranch_scc0 L_pl_19
L_pd_20:
s_mov_b64 exec, -1
L_po_17:
s_barrier
s_add_u32 m0, s93, 0
buffer_load_dwordx4 v236, s[8:11], s88 offen sc1 lds
s_add_u32 m0, s93, 8192
buffer_load_dwordx4 v236, s[8:11], s89 offen sc1 lds
s_add_u32 m0, s93, 16384
buffer_load_dwordx4 v236, s[8:11], s90 offen sc1 lds
s_add_u32 m0, s93, 24576
buffer_load_dwordx4 v236, s[8:11], s91 offen sc1 lds
s_add_u32 m0, s93, 32768
buffer_load_dwordx4 v236, s[8:11], s92 offen sc1 lds
s_add_u32 m0, s93, 40960
buffer_load_dwordx4 v3, s[8:11], s88 offen sc1 lds
s_add_u32 m0, s93, 49152
buffer_load_dwordx4 v3, s[8:11], s89 offen sc1 lds
s_add_u32 m0, s93, 57344
buffer_load_dwordx4 v3, s[8:11], s90 offen sc1 lds
s_add_u32 m0, s93, 65536
buffer_load_dwordx4 v3, s[8:11], s91 offen sc1 lds
s_add_u32 m0, s93, 73728
buffer_load_dwordx4 v3, s[8:11], s92 offen sc1 lds
s_waitcnt vmcnt(5)
s_barrier
ds_read_b128 v[40:43], v4 offset:32768
ds_read_b128 v[8:11], v4 offset:0
ds_read_b128 v[12:15], v4 offset:4096
ds_read_b128 v[16:19], v4 offset:8192
ds_read_b128 v[20:23], v4 offset:12288
ds_read_b128 v[24:27], v4 offset:16384
ds_read_b128 v[28:31], v4 offset:20480
ds_read_b128 v[32:35], v4 offset:24576
ds_read_b128 v[36:39], v4 offset:28672
s_cmp_lg_u32 s30, 0
s_cbranch_scc1 L_p2slow_23
s_waitcnt lgkmcnt(7)
v_mfma_f32_32x32x16_bf16 v[156:171], v[40:43], v[244:247], 0
v_mfma_f32_32x32x16_bf16 v[140:155], v[8:11], v[244:247], 0
s_waitcnt lgkmcnt(6)
v_mfma_f32_32x32x16_bf16 v[172:187], v[12:15], v[244:247], 0
s_nop 11
v_bfi_b32 v140, v116, v156, v140
v_bfi_b32 v141, v117, v157, v141
v_bfi_b32 v142, v118, v158, v142
v_bfi_b32 v143, v119, v159, v143
v_bfi_b32 v144, v120, v160, v144
v_bfi_b32 v145, v121, v161, v145
v_bfi_b32 v146, v122, v162, v146
v_bfi_b32 v147, v123, v163, v147
v_bfi_b32 v148, v124, v164, v148
v_bfi_b32 v149, v125, v165, v149
v_bfi_b32 v150, v126, v166, v150
v_bfi_b32 v151, v127, v167, v151
v_bfi_b32 v152, v128, v168, v152
v_bfi_b32 v153, v129, v169, v153
v_bfi_b32 v154, v130, v170, v154
v_bfi_b32 v155, v131, v171, v155
s_waitcnt lgkmcnt(5)
v_mfma_f32_32x32x16_bf16 v[156:171], v[16:19], v[244:247], 0
v_max_f32 v241, v140, v141
v_max_f32 v242, v142, v143
v_max3_f32 v241, v144, v145, v241
v_max3_f32 v242, v146, v147, v242
v_max3_f32 v241, v148, v149, v241
v_max3_f32 v242, v150, v151, v242
v_max3_f32 v241, v152, v153, v241
v_max3_f32 v242, v154, v155, v242
s_waitcnt lgkmcnt(4)
v_mfma_f32_32x32x16_bf16 v[140:155], v[20:23], v[244:247], 0
v_max3_f32 v241, v172, v173, v241
v_max3_f32 v242, v174, v175, v242
v_max3_f32 v241, v176, v177, v241
v_max3_f32 v242, v178, v179, v242
v_max3_f32 v241, v180, v181, v241
v_max3_f32 v242, v182, v183, v242
v_max3_f32 v241, v184, v185, v241
v_max3_f32 v242, v186, v187, v242
s_waitcnt lgkmcnt(3)
v_mfma_f32_32x32x16_bf16 v[172:187], v[24:27], v[244:247], 0
v_max3_f32 v241, v156, v157, v241
v_max3_f32 v242, v158, v159, v242
v_max3_f32 v241, v160, v161, v241
v_max3_f32 v242, v162, v163, v242
v_max3_f32 v241, v164, v165, v241
v_max3_f32 v242, v166, v167, v242
v_max3_f32 v241, v168, v169, v241
v_max3_f32 v242, v170, v171, v242
s_waitcnt lgkmcnt(2)
v_mfma_f32_32x32x16_bf16 v[156:171], v[28:31], v[244:247], 0
v_max3_f32 v241, v140, v141, v241
v_max3_f32 v242, v142, v143, v242
v_max3_f32 v241, v144, v145, v241
v_max3_f32 v242, v146, v147, v242
v_max3_f32 v241, v148, v149, v241
v_max3_f32 v242, v150, v151, v242
v_max3_f32 v241, v152, v153, v241
v_max3_f32 v242, v154, v155, v242
s_waitcnt lgkmcnt(1)
v_mfma_f32_32x32x16_bf16 v[140:155], v[32:35], v[244:247], 0
v_max3_f32 v241, v172, v173, v241
v_max3_f32 v242, v174, v175, v242
v_max3_f32 v241, v176, v177, v241
v_max3_f32 v242, v178, v179, v242
v_max3_f32 v241, v180, v181, v241
v_max3_f32 v242, v182, v183, v242
v_max3_f32 v241, v184, v185, v241
v_max3_f32 v242, v186, v187, v242
s_waitcnt lgkmcnt(0)
v_mfma_f32_32x32x16_bf16 v[172:187], v[36:39], v[244:247], 0
v_max3_f32 v241, v156, v157, v241
v_max3_f32 v242, v158, v159, v242
v_max3_f32 v241, v160, v161, v241
v_max3_f32 v242, v162, v163, v242
v_max3_f32 v241, v164, v165, v241
v_max3_f32 v242, v166, v167, v242
v_max3_f32 v241, v168, v169, v241
v_max3_f32 v242, v170, v171, v242
s_waitcnt vmcnt(0) lgkmcnt(0)
s_barrier
s_mov_b32 s36, 0x0000ffff
s_mov_b32 s37, 0x0000ffff
s_mov_b64 exec, s[36:37]
ds_read_b128 v[108:111], v5 offset:32768
ds_read_b128 v[112:115], v5 offset:33280
ds_read_b128 v[44:47], v5 offset:0
ds_read_b128 v[48:51], v5 offset:512
ds_read_b128 v[52:55], v5 offset:4096
ds_read_b128 v[56:59], v5 offset:4608
ds_read_b128 v[60:63], v5 offset:8192
ds_read_b128 v[64:67], v5 offset:8704
ds_read_b128 v[68:71], v5 offset:12288
ds_read_b128 v[72:75], v5 offset:12800
ds_read_b128 v[76:79], v5 offset:16384
ds_read_b128 v[80:83], v5 offset:16896
ds_read_b128 v[84:87], v5 offset:20480
ds_read_b128 v[88:91], v5 offset:20992
ds_read_b128 v[92:95], v5 offset:24576
ds_read_b128 v[96:99], v5 offset:25088
ds_read_b128 v[100:103], v5 offset:28672
ds_read_b128 v[104:107], v5 offset:29184
s_mov_b64 exec, -1
v_max3_f32 v241, v140, v141, v241
v_max3_f32 v242, v142, v143, v242
v_max3_f32 v241, v144, v145, v241
v_max3_f32 v242, v146, v147, v242
v_max3_f32 v241, v148, v149, v241
v_max3_f32 v242, v150, v151, v242
v_max3_f32 v241, v152, v153, v241
v_max3_f32 v242, v154, v155, v242
v_max3_f32 v241, v172, v173, v241
v_max3_f32 v242, v174, v175, v242
v_max3_f32 v241, v176, v177, v241
v_max3_f32 v242, v178, v179, v242
v_max3_f32 v241, v180, v181, v241
v_max3_f32 v242, v182, v183, v242
v_max3_f32 v241, v184, v185, v241
v_max3_f32 v242, v186, v187, v242
v_max_f32 v241, v241, v242
v_mov_b32 v242, v241
s_nop 1
v_permlane32_swap_b32 v241, v242
s_nop 1
v_max_f32 v241, v241, v242
v_sub_f32 v188, 0, v241
v_sub_f32 v189, 0, v241
v_sub_f32 v190, 0, v241
v_sub_f32 v191, 0, v241
v_sub_f32 v192, 0, v241
v_sub_f32 v193, 0, v241
v_sub_f32 v194, 0, v241
v_sub_f32 v195, 0, v241
v_sub_f32 v196, 0, v241
v_sub_f32 v197, 0, v241
v_sub_f32 v198, 0, v241
v_sub_f32 v199, 0, v241
v_sub_f32 v200, 0, v241
v_sub_f32 v201, 0, v241
v_sub_f32 v202, 0, v241
v_sub_f32 v203, 0, v241
s_mov_b32 s16, s76
s_mov_b32 s17, s77
s_mov_b32 s18, 1409024
s_mov_b32 s19, 0x20000
s_and_b32 s6, s3, 3
s_lshl_b32 s6, s6, 3
s_add_u32 s6, s6, s4
s_lshl_b32 s6, s6, 3
s_add_u32 s6, s6, s5
s_mul_i32 s6, s6, 5504
v_lshlrev_b32 v243, 7, v1
s_mov_b32 exec_hi, 0x7ff
buffer_load_dword v252, v243, s[16:19], s6 offen
s_mov_b64 exec, -1
s_nop 1
v_mfma_f32_32x32x16_bf16 v[156:171], v[40:43], v[244:247], v[188:203]
v_mfma_f32_32x32x16_bf16 v[140:155], v[8:11], v[244:247], v[188:203]
v_mfma_f32_32x32x16_bf16 v[172:187], v[12:15], v[244:247], v[188:203]
s_nop 11
v_bfi_b32 v140, v116, v156, v140
v_bfi_b32 v141, v117, v157, v141
v_bfi_b32 v142, v118, v158, v142
v_bfi_b32 v143, v119, v159, v143
v_bfi_b32 v144, v120, v160, v144
v_bfi_b32 v145, v121, v161, v145
v_bfi_b32 v146, v122, v162, v146
v_bfi_b32 v147, v123, v163, v147
v_bfi_b32 v148, v124, v164, v148
v_bfi_b32 v149, v125, v165, v149
v_bfi_b32 v150, v126, v166, v150
v_bfi_b32 v151, v127, v167, v151
v_bfi_b32 v152, v128, v168, v152
v_bfi_b32 v153, v129, v169, v153
v_bfi_b32 v154, v130, v170, v154
v_bfi_b32 v155, v131, v171, v155
v_mfma_f32_32x32x16_bf16 v[156:171], v[16:19], v[244:247], v[188:203]
v_exp_f32 v140, v140
v_exp_f32 v141, v141
v_exp_f32 v142, v142
v_exp_f32 v143, v143
v_exp_f32 v144, v144
v_exp_f32 v145, v145
v_exp_f32 v146, v146
v_exp_f32 v147, v147
v_exp_f32 v148, v148
v_exp_f32 v149, v149
v_exp_f32 v150, v150
v_exp_f32 v151, v151
v_exp_f32 v152, v152
v_exp_f32 v153, v153
v_exp_f32 v154, v154
v_exp_f32 v155, v155
s_nop 0
v_cvt_pk_bf16_f32 v220, v140, v141
v_cvt_pk_bf16_f32 v221, v142, v143
v_cvt_pk_bf16_f32 v222, v144, v145
v_cvt_pk_bf16_f32 v223, v146, v147
v_cvt_pk_bf16_f32 v224, v148, v149
v_cvt_pk_bf16_f32 v225, v150, v151
v_cvt_pk_bf16_f32 v226, v152, v153
v_cvt_pk_bf16_f32 v227, v154, v155
v_and_b32 v228, v220, v132
v_and_b32 v229, v221, v133
v_and_b32 v230, v222, v134
v_and_b32 v231, v223, v135
v_and_b32 v232, v224, v136
v_and_b32 v233, v225, v137
v_and_b32 v234, v226, v138
v_and_b32 v235, v227, v139
v_xor_b32 v220, v220, v228
v_xor_b32 v221, v221, v229
v_xor_b32 v222, v222, v230
v_xor_b32 v223, v223, v231
v_xor_b32 v224, v224, v232
v_xor_b32 v225, v225, v233
v_xor_b32 v226, v226, v234
v_xor_b32 v227, v227, v235
s_waitcnt lgkmcnt(14)
v_mfma_f32_32x32x16_bf16 v[204:219], v[108:111], v[228:231], 0
v_mfma_f32_32x32x16_bf16 v[204:219], v[112:115], v[232:235], v[204:219]
v_exp_f32 v172, v172
v_exp_f32 v173, v173
v_exp_f32 v174, v174
v_exp_f32 v175, v175
v_exp_f32 v176, v176
v_exp_f32 v177, v177
v_exp_f32 v178, v178
v_exp_f32 v179, v179
v_mfma_f32_32x32x16_bf16 v[204:219], v[44:47], v[220:223], v[204:219]
v_mfma_f32_32x32x16_bf16 v[204:219], v[48:51], v[224:227], v[204:219]
v_mfma_f32_32x32x16_bf16 v[140:155], v[20:23], v[244:247], v[188:203]
v_exp_f32 v180, v180
v_exp_f32 v181, v181
v_exp_f32 v182, v182
v_exp_f32 v183, v183
v_exp_f32 v184, v184
v_exp_f32 v185, v185
v_exp_f32 v186, v186
v_exp_f32 v187, v187
s_nop 0
v_cvt_pk_bf16_f32 v228, v172, v173
v_cvt_pk_bf16_f32 v229, v174, v175
v_cvt_pk_bf16_f32 v230, v176, v177
v_cvt_pk_bf16_f32 v231, v178, v179
v_cvt_pk_bf16_f32 v232, v180, v181
v_cvt_pk_bf16_f32 v233, v182, v183
v_cvt_pk_bf16_f32 v234, v184, v185
v_cvt_pk_bf16_f32 v235, v186, v187
s_nop 1
s_waitcnt lgkmcnt(12)
v_mfma_f32_32x32x16_bf16 v[204:219], v[52:55], v[228:231], v[204:219]
v_mfma_f32_32x32x16_bf16 v[204:219], v[56:59], v[232:235], v[204:219]
v_exp_f32 v156, v156
v_exp_f32 v157, v157
v_exp_f32 v158, v158
v_exp_f32 v159, v159
v_exp_f32 v160, v160
v_exp_f32 v161, v161
v_exp_f32 v162, v162
v_exp_f32 v163, v163
v_mfma_f32_32x32x16_bf16 v[172:187], v[24:27], v[244:247], v[188:203]
v_exp_f32 v164, v164
v_exp_f32 v165, v165
v_exp_f32 v166, v166
v_exp_f32 v167, v167
v_exp_f32 v168, v168
v_exp_f32 v169, v169
v_exp_f32 v170, v170
v_exp_f32 v171, v171
s_nop 0
v_cvt_pk_bf16_f32 v220, v156, v157
v_cvt_pk_bf16_f32 v221, v158, v159
v_cvt_pk_bf16_f32 v222, v160, v161
v_cvt_pk_bf16_f32 v223, v162, v163
v_cvt_pk_bf16_f32 v224, v164, v165
v_cvt_pk_bf16_f32 v225, v166, v167
v_cvt_pk_bf16_f32 v226, v168, v169
v_cvt_pk_bf16_f32 v227, v170, v171
s_nop 1
s_waitcnt lgkmcnt(10)
v_mfma_f32_32x32x16_bf16 v[204:219], v[60:63], v[220:223], v[204:219]
v_mfma_f32_32x32x16_bf16 v[204:219], v[64:67], v[224:227], v[204:219]
v_exp_f32 v140, v140
v_exp_f32 v141, v141
v_exp_f32 v142, v142
v_exp_f32 v143, v143
v_exp_f32 v144, v144
v_exp_f32 v145, v145
v_exp_f32 v146, v146
v_exp_f32 v147, v147
v_mfma_f32_32x32x16_bf16 v[156:171], v[28:31], v[244:247], v[188:203]
v_exp_f32 v148, v148
v_exp_f32 v149, v149
v_exp_f32 v150, v150
v_exp_f32 v151, v151
v_exp_f32 v152, v152
v_exp_f32 v153, v153
v_exp_f32 v154, v154
v_exp_f32 v155, v155
s_nop 0
v_cvt_pk_bf16_f32 v228, v140, v141
v_cvt_pk_bf16_f32 v229, v142, v143
v_cvt_pk_bf16_f32 v230, v144, v145
v_cvt_pk_bf16_f32 v231, v146, v147
v_cvt_pk_bf16_f32 v232, v148, v149
v_cvt_pk_bf16_f32 v233, v150, v151
v_cvt_pk_bf16_f32 v234, v152, v153
v_cvt_pk_bf16_f32 v235, v154, v155
s_nop 1
s_waitcnt lgkmcnt(8)
v_mfma_f32_32x32x16_bf16 v[204:219], v[68:71], v[228:231], v[204:219]
v_mfma_f32_32x32x16_bf16 v[204:219], v[72:75], v[232:235], v[204:219]
v_exp_f32 v172, v172
v_exp_f32 v173, v173
v_exp_f32 v174, v174
v_exp_f32 v175, v175
v_exp_f32 v176, v176
v_exp_f32 v177, v177
v_exp_f32 v178, v178
v_exp_f32 v179, v179
v_mfma_f32_32x32x16_bf16 v[140:155], v[32:35], v[244:247], v[188:203]
v_exp_f32 v180, v180
v_exp_f32 v181, v181
v_exp_f32 v182, v182
v_exp_f32 v183, v183
v_exp_f32 v184, v184
v_exp_f32 v185, v185
v_exp_f32 v186, v186
v_exp_f32 v187, v187
s_nop 0
v_cvt_pk_bf16_f32 v220, v172, v173
v_cvt_pk_bf16_f32 v221, v174, v175
v_cvt_pk_bf16_f32 v222, v176, v177
v_cvt_pk_bf16_f32 v223, v178, v179
v_cvt_pk_bf16_f32 v224, v180, v181
v_cvt_pk_bf16_f32 v225, v182, v183
v_cvt_pk_bf16_f32 v226, v184, v185
v_cvt_pk_bf16_f32 v227, v186, v187
s_nop 1
s_waitcnt lgkmcnt(6)
v_mfma_f32_32x32x16_bf16 v[204:219], v[76:79], v[220:223], v[204:219]
v_mfma_f32_32x32x16_bf16 v[204:219], v[80:83], v[224:227], v[204:219]
v_exp_f32 v156, v156
v_exp_f32 v157, v157
v_exp_f32 v158, v158
v_exp_f32 v159, v159
v_exp_f32 v160, v160
v_exp_f32 v161, v161
v_exp_f32 v162, v162
v_exp_f32 v163, v163
v_mfma_f32_32x32x16_bf16 v[172:187], v[36:39], v[244:247], v[188:203]
v_exp_f32 v164, v164
v_exp_f32 v165, v165
v_exp_f32 v166, v166
v_exp_f32 v167, v167
v_exp_f32 v168, v168
v_exp_f32 v169, v169
v_exp_f32 v170, v170
v_exp_f32 v171, v171
s_nop 0
v_cvt_pk_bf16_f32 v228, v156, v157
v_cvt_pk_bf16_f32 v229, v158, v159
v_cvt_pk_bf16_f32 v230, v160, v161
v_cvt_pk_bf16_f32 v231, v162, v163
v_cvt_pk_bf16_f32 v232, v164, v165
v_cvt_pk_bf16_f32 v233, v166, v167
v_cvt_pk_bf16_f32 v234, v168, v169
v_cvt_pk_bf16_f32 v235, v170, v171
s_nop 1
s_waitcnt lgkmcnt(4)
v_mfma_f32_32x32x16_bf16 v[204:219], v[84:87], v[228:231], v[204:219]
v_mfma_f32_32x32x16_bf16 v[204:219], v[88:91], v[232:235], v[204:219]
v_exp_f32 v140, v140
v_exp_f32 v141, v141
v_exp_f32 v142, v142
v_exp_f32 v143, v143
v_exp_f32 v144, v144
v_exp_f32 v145, v145
v_exp_f32 v146, v146
v_exp_f32 v147, v147
v_exp_f32 v148, v148
v_exp_f32 v149, v149
v_exp_f32 v150, v150
v_exp_f32 v151, v151
v_exp_f32 v152, v152
v_exp_f32 v153, v153
v_exp_f32 v154, v154
v_exp_f32 v155, v155
s_nop 0
v_cvt_pk_bf16_f32 v220, v140, v141
v_cvt_pk_bf16_f32 v221, v142, v143
v_cvt_pk_bf16_f32 v222, v144, v145
v_cvt_pk_bf16_f32 v223, v146, v147
v_cvt_pk_bf16_f32 v224, v148, v149
v_cvt_pk_bf16_f32 v225, v150, v151
v_cvt_pk_bf16_f32 v226, v152, v153
v_cvt_pk_bf16_f32 v227, v154, v155
s_nop 1
s_waitcnt lgkmcnt(2)
v_mfma_f32_32x32x16_bf16 v[204:219], v[92:95], v[220:223], v[204:219]
v_mfma_f32_32x32x16_bf16 v[204:219], v[96:99], v[224:227], v[204:219]
v_exp_f32 v172, v172
v_exp_f32 v173, v173
v_exp_f32 v174, v174
v_exp_f32 v175, v175
v_exp_f32 v176, v176
v_exp_f32 v177, v177
v_exp_f32 v178, v178
v_exp_f32 v179, v179
v_exp_f32 v180, v180
v_exp_f32 v181, v181
v_exp_f32 v182, v182
v_exp_f32 v183, v183
v_exp_f32 v184, v184
v_exp_f32 v185, v185
v_exp_f32 v186, v186
v_exp_f32 v187, v187
s_nop 0
v_cvt_pk_bf16_f32 v228, v172, v173
v_cvt_pk_bf16_f32 v229, v174, v175
v_cvt_pk_bf16_f32 v230, v176, v177
v_cvt_pk_bf16_f32 v231, v178, v179
v_cvt_pk_bf16_f32 v232, v180, v181
v_cvt_pk_bf16_f32 v233, v182, v183
v_cvt_pk_bf16_f32 v234, v184, v185
v_cvt_pk_bf16_f32 v235, v186, v187
s_nop 1
s_waitcnt lgkmcnt(0)
v_mfma_f32_32x32x16_bf16 v[204:219], v[100:103], v[228:231], v[204:219]
v_mfma_f32_32x32x16_bf16 v[204:219], v[104:107], v[232:235], v[204:219]
s_branch L_p2join_22
L_p2slow_23:
s_waitcnt lgkmcnt(7)
v_mfma_f32_32x32x16_bf16 v[156:171], v[40:43], v[244:247], 0
s_cmp_lg_u32 s30, 0
s_cbranch_scc1 L_t0inv_24
v_mfma_f32_32x32x16_bf16 v[140:155], v[8:11], v[244:247], 0
s_branch L_t0done_25
L_t0inv_24:
v_mov_b32 v140, 0xf149f2ca
v_mov_b32 v141, 0xf149f2ca
v_mov_b32 v142, 0xf149f2ca
v_mov_b32 v143, 0xf149f2ca
v_mov_b32 v144, 0xf149f2ca
v_mov_b32 v145, 0xf149f2ca
v_mov_b32 v146, 0xf149f2ca
v_mov_b32 v147, 0xf149f2ca
v_mov_b32 v148, 0xf149f2ca
v_mov_b32 v149, 0xf149f2ca
v_mov_b32 v150, 0xf149f2ca
v_mov_b32 v151, 0xf149f2ca
v_mov_b32 v152, 0xf149f2ca
v_mov_b32 v153, 0xf149f2ca
v_mov_b32 v154, 0xf149f2ca
v_mov_b32 v155, 0xf149f2ca
L_t0done_25:
s_nop 15
v_bfi_b32 v140, v116, v156, v140
v_bfi_b32 v141, v117, v157, v141
v_bfi_b32 v142, v118, v158, v142
v_bfi_b32 v143, v119, v159, v143
v_bfi_b32 v144, v120, v160, v144
v_bfi_b32 v145, v121, v161, v145
v_bfi_b32 v146, v122, v162, v146
v_bfi_b32 v147, v123, v163, v147
v_bfi_b32 v148, v124, v164, v148
v_bfi_b32 v149, v125, v165, v149
v_bfi_b32 v150, v126, v166, v150
v_bfi_b32 v151, v127, v167, v151
v_bfi_b32 v152, v128, v168, v152
v_bfi_b32 v153, v129, v169, v153
v_bfi_b32 v154, v130, v170, v154
v_bfi_b32 v155, v131, v171, v155
v_max_f32 v241, v140, v141
v_max_f32 v242, v142, v143
v_max3_f32 v241, v144, v145, v241
v_max3_f32 v242, v146, v147, v242
v_max3_f32 v241, v148, v149, v241
v_max3_f32 v242, v150, v151, v242
v_max3_f32 v241, v152, v153, v241
v_max3_f32 v242, v154, v155, v242
s_cmp_gt_u32 s30, 1
s_cbranch_scc1 L_skip1_26
s_waitcnt lgkmcnt(6)
v_mfma_f32_32x32x16_bf16 v[156:171], v[12:15], v[244:247], 0
s_nop 15
v_max3_f32 v241, v156, v157, v241
v_max3_f32 v242, v158, v159, v242
v_max3_f32 v241, v160, v161, v241
v_max3_f32 v242, v162, v163, v242
v_max3_f32 v241, v164, v165, v241
v_max3_f32 v242, v166, v167, v242
v_max3_f32 v241, v168, v169, v241
v_max3_f32 v242, v170, v171, v242
L_skip1_26:
s_cmp_gt_u32 s30, 2
s_cbranch_scc1 L_skip1_27
s_waitcnt lgkmcnt(5)
v_mfma_f32_32x32x16_bf16 v[172:187], v[16:19], v[244:247], 0
s_nop 15
v_max3_f32 v241, v172, v173, v241
v_max3_f32 v242, v174, v175, v242
v_max3_f32 v241, v176, v177, v241
v_max3_f32 v242, v178, v179, v242
v_max3_f32 v241, v180, v181, v241
v_max3_f32 v242, v182, v183, v242
v_max3_f32 v241, v184, v185, v241
v_max3_f32 v242, v186, v187, v242
L_skip1_27:
s_cmp_gt_u32 s30, 3
s_cbranch_scc1 L_skip1_28
s_waitcnt lgkmcnt(4)
v_mfma_f32_32x32x16_bf16 v[156:171], v[20:23], v[244:247], 0
s_nop 15
v_max3_f32 v241, v156, v157, v241
v_max3_f32 v242, v158, v159, v242
v_max3_f32 v241, v160, v161, v241
v_max3_f32 v242, v162, v163, v242
v_max3_f32 v241, v164, v165, v241
v_max3_f32 v242, v166, v167, v242
v_max3_f32 v241, v168, v169, v241
v_max3_f32 v242, v170, v171, v242
L_skip1_28:
s_cmp_gt_u32 s30, 4
s_cbranch_scc1 L_skip1_29
s_waitcnt lgkmcnt(3)
v_mfma_f32_32x32x16_bf16 v[172:187], v[24:27], v[244:247], 0
s_nop 15
v_max3_f32 v241, v172, v173, v241
v_max3_f32 v242, v174, v175, v242
v_max3_f32 v241, v176, v177, v241
v_max3_f32 v242, v178, v179, v242
v_max3_f32 v241, v180, v181, v241
v_max3_f32 v242, v182, v183, v242
v_max3_f32 v241, v184, v185, v241
v_max3_f32 v242, v186, v187, v242
L_skip1_29:
s_cmp_gt_u32 s30, 5
s_cbranch_scc1 L_skip1_30
s_waitcnt lgkmcnt(2)
v_mfma_f32_32x32x16_bf16 v[156:171], v[28:31], v[244:247], 0
s_nop 15
v_max3_f32 v241, v156, v157, v241
v_max3_f32 v242, v158, v159, v242
v_max3_f32 v241, v160, v161, v241
v_max3_f32 v242, v162, v163, v242
v_max3_f32 v241, v164, v165, v241
v_max3_f32 v242, v166, v167, v242
v_max3_f32 v241, v168, v169, v241
v_max3_f32 v242, v170, v171, v242
L_skip1_30:
s_cmp_gt_u32 s30, 6
s_cbranch_scc1 L_skip1_31
s_waitcnt lgkmcnt(1)
v_mfma_f32_32x32x16_bf16 v[172:187], v[32:35], v[244:247], 0
s_nop 15
v_max3_f32 v241, v172, v173, v241
v_max3_f32 v242, v174, v175, v242
v_max3_f32 v241, v176, v177, v241
v_max3_f32 v242, v178, v179, v242
v_max3_f32 v241, v180, v181, v241
v_max3_f32 v242, v182, v183, v242
v_max3_f32 v241, v184, v185, v241
v_max3_f32 v242, v186, v187, v242
L_skip1_31:
s_cmp_gt_u32 s30, 7
s_cbranch_scc1 L_skip1_32
s_waitcnt lgkmcnt(0)
v_mfma_f32_32x32x16_bf16 v[156:171], v[36:39], v[244:247], 0
s_nop 15
v_max3_f32 v241, v156, v157, v241
v_max3_f32 v242, v158, v159, v242
v_max3_f32 v241, v160, v161, v241
v_max3_f32 v242, v162, v163, v242
v_max3_f32 v241, v164, v165, v241
v_max3_f32 v242, v166, v167, v242
v_max3_f32 v241, v168, v169, v241
v_max3_f32 v242, v170, v171, v242
L_skip1_32:
s_waitcnt vmcnt(0) lgkmcnt(0)
s_barrier
s_mov_b32 s36, 0x0000ffff
s_mov_b32 s37, 0x0000ffff
s_mov_b64 exec, s[36:37]
ds_read_b128 v[108:111], v5 offset:32768
ds_read_b128 v[112:115], v5 offset:33280
ds_read_b128 v[44:47], v5 offset:0
ds_read_b128 v[48:51], v5 offset:512
ds_read_b128 v[52:55], v5 offset:4096
ds_read_b128 v[56:59], v5 offset:4608
ds_read_b128 v[60:63], v5 offset:8192
ds_read_b128 v[64:67], v5 offset:8704
ds_read_b128 v[68:71], v5 offset:12288
ds_read_b128 v[72:75], v5 offset:12800
ds_read_b128 v[76:79], v5 offset:16384
ds_read_b128 v[80:83], v5 offset:16896
ds_read_b128 v[84:87], v5 offset:20480
ds_read_b128 v[88:91], v5 offset:20992
ds_read_b128 v[92:95], v5 offset:24576
ds_read_b128 v[96:99], v5 offset:25088
ds_read_b128 v[100:103], v5 offset:28672
ds_read_b128 v[104:107], v5 offset:29184
s_mov_b64 exec, -1
v_max_f32 v241, v241, v242
v_mov_b32 v242, v241
s_nop 1
v_permlane32_swap_b32 v241, v242
s_nop 1
v_max_f32 v241, v241, v242
v_sub_f32 v188, 0, v241
v_sub_f32 v189, 0, v241
v_sub_f32 v190, 0, v241
v_sub_f32 v191, 0, v241
v_sub_f32 v192, 0, v241
v_sub_f32 v193, 0, v241
v_sub_f32 v194, 0, v241
v_sub_f32 v195, 0, v241
v_sub_f32 v196, 0, v241
v_sub_f32 v197, 0, v241
v_sub_f32 v198, 0, v241
v_sub_f32 v199, 0, v241
v_sub_f32 v200, 0, v241
v_sub_f32 v201, 0, v241
v_sub_f32 v202, 0, v241
v_sub_f32 v203, 0, v241
v_mov_b32 v204, 0
v_mov_b32 v205, 0
v_mov_b32 v206, 0
v_mov_b32 v207, 0
v_mov_b32 v208, 0
v_mov_b32 v209, 0
v_mov_b32 v210, 0
v_mov_b32 v211, 0
v_mov_b32 v212, 0
v_mov_b32 v213, 0
v_mov_b32 v214, 0
v_mov_b32 v215, 0
v_mov_b32 v216, 0
v_mov_b32 v217, 0
v_mov_b32 v218, 0
v_mov_b32 v219, 0
s_waitcnt vmcnt(0)
s_mov_b32 s16, s76
s_mov_b32 s17, s77
s_mov_b32 s18, 1409024
s_mov_b32 s19, 0x20000
s_and_b32 s6, s3, 3
s_lshl_b32 s6, s6, 3
s_add_u32 s6, s6, s4
s_lshl_b32 s6, s6, 3
s_add_u32 s6, s6, s5
s_mul_i32 s6, s6, 5504
v_lshlrev_b32 v140, 7, v1
s_mov_b32 exec_hi, 0x7ff
buffer_load_dword v252, v140, s[16:19], s6 offen
s_mov_b64 exec, -1
s_nop 1
v_mfma_f32_32x32x16_bf16 v[156:171], v[40:43], v[244:247], v[188:203]
s_cmp_lg_u32 s30, 0
s_cbranch_scc1 L_t0inv_33
v_mfma_f32_32x32x16_bf16 v[140:155], v[8:11], v[244:247], v[188:203]
s_branch L_t0done_34
L_t0inv_33:
v_mov_b32 v140, 0xf149f2ca
v_mov_b32 v141, 0xf149f2ca
v_mov_b32 v142, 0xf149f2ca
v_mov_b32 v143, 0xf149f2ca
v_mov_b32 v144, 0xf149f2ca
v_mov_b32 v145, 0xf149f2ca
v_mov_b32 v146, 0xf149f2ca
v_mov_b32 v147, 0xf149f2ca
v_mov_b32 v148, 0xf149f2ca
v_mov_b32 v149, 0xf149f2ca
v_mov_b32 v150, 0xf149f2ca
v_mov_b32 v151, 0xf149f2ca
v_mov_b32 v152, 0xf149f2ca
v_mov_b32 v153, 0xf149f2ca
v_mov_b32 v154, 0xf149f2ca
v_mov_b32 v155, 0xf149f2ca
L_t0done_34:
s_nop 15
v_bfi_b32 v140, v116, v156, v140
v_bfi_b32 v141, v117, v157, v141
v_bfi_b32 v142, v118, v158, v142
v_bfi_b32 v143, v119, v159, v143
v_bfi_b32 v144, v120, v160, v144
v_bfi_b32 v145, v121, v161, v145
v_bfi_b32 v146, v122, v162, v146
v_bfi_b32 v147, v123, v163, v147
v_bfi_b32 v148, v124, v164, v148
v_bfi_b32 v149, v125, v165, v149
v_bfi_b32 v150, v126, v166, v150
v_bfi_b32 v151, v127, v167, v151
v_bfi_b32 v152, v128, v168, v152
v_bfi_b32 v153, v129, v169, v153
v_bfi_b32 v154, v130, v170, v154
v_bfi_b32 v155, v131, v171, v155
v_exp_f32 v140, v140
v_exp_f32 v141, v141
v_exp_f32 v142, v142
v_exp_f32 v143, v143
v_exp_f32 v144, v144
v_exp_f32 v145, v145
v_exp_f32 v146, v146
v_exp_f32 v147, v147
v_exp_f32 v148, v148
v_exp_f32 v149, v149
v_exp_f32 v150, v150
v_exp_f32 v151, v151
v_exp_f32 v152, v152
v_exp_f32 v153, v153
v_exp_f32 v154, v154
v_exp_f32 v155, v155
s_nop 0
v_cvt_pk_bf16_f32 v220, v140, v141
v_cvt_pk_bf16_f32 v221, v142, v143
v_cvt_pk_bf16_f32 v222, v144, v145
v_cvt_pk_bf16_f32 v223, v146, v147
v_cvt_pk_bf16_f32 v224, v148, v149
v_cvt_pk_bf16_f32 v225, v150, v151
v_cvt_pk_bf16_f32 v226, v152, v153
v_cvt_pk_bf16_f32 v227, v154, v155
v_and_b32 v228, v220, v132
v_xor_b32 v220, v220, v228
v_and_b32 v229, v221, v133
v_xor_b32 v221, v221, v229
v_and_b32 v230, v222, v134
v_xor_b32 v222, v222, v230
v_and_b32 v231, v223, v135
v_xor_b32 v223, v223, v231
v_and_b32 v232, v224, v136
v_xor_b32 v224, v224, v232
v_and_b32 v233, v225, v137
v_xor_b32 v225, v225, v233
v_and_b32 v234, v226, v138
v_xor_b32 v226, v226, v234
v_and_b32 v235, v227, v139
v_xor_b32 v227, v227, v235
s_nop 1
s_waitcnt lgkmcnt(14)
v_mfma_f32_32x32x16_bf16 v[204:219], v[108:111], v[228:231], v[204:219]
v_mfma_f32_32x32x16_bf16 v[204:219], v[112:115], v[232:235], v[204:219]
s_cmp_lg_u32 s30, 0
s_cbranch_scc1 L_nov0_35
v_mfma_f32_32x32x16_bf16 v[204:219], v[44:47], v[220:223], v[204:219]
v_mfma_f32_32x32x16_bf16 v[204:219], v[48:51], v[224:227], v[204:219]
L_nov0_35:
s_cmp_gt_u32 s30, 1
s_cbranch_scc1 L_skip2_36
v_mfma_f32_32x32x16_bf16 v[156:171], v[12:15], v[244:247], v[188:203]
s_nop 15
v_exp_f32 v156, v156
v_exp_f32 v157, v157
v_exp_f32 v158, v158
v_exp_f32 v159, v159
v_exp_f32 v160, v160
v_exp_f32 v161, v161
v_exp_f32 v162, v162
v_exp_f32 v163, v163
v_exp_f32 v164, v164
v_exp_f32 v165, v165
v_exp_f32 v166, v166
v_exp_f32 v167, v167
v_exp_f32 v168, v168
v_exp_f32 v169, v169
v_exp_f32 v170, v170
v_exp_f32 v171, v171
s_nop 0
v_cvt_pk_bf16_f32 v228, v156, v157
v_cvt_pk_bf16_f32 v229, v158, v159
v_cvt_pk_bf16_f32 v230, v160, v161
v_cvt_pk_bf16_f32 v231, v162, v163
v_cvt_pk_bf16_f32 v232, v164, v165
v_cvt_pk_bf16_f32 v233, v166, v167
v_cvt_pk_bf16_f32 v234, v168, v169
v_cvt_pk_bf16_f32 v235, v170, v171
s_nop 1
s_waitcnt lgkmcnt(12)
v_mfma_f32_32x32x16_bf16 v[204:219], v[52:55], v[228:231], v[204:219]
v_mfma_f32_32x32x16_bf16 v[204:219], v[56:59], v[232:235], v[204:219]
L_skip2_36:
s_cmp_gt_u32 s30, 2
s_cbranch_scc1 L_skip2_37
v_mfma_f32_32x32x16_bf16 v[172:187], v[16:19], v[244:247], v[188:203]
s_nop 15
v_exp_f32 v172, v172
v_exp_f32 v173, v173
v_exp_f32 v174, v174
v_exp_f32 v175, v175
v_exp_f32 v176, v176
v_exp_f32 v177, v177
v_exp_f32 v178, v178
v_exp_f32 v179, v179
v_exp_f32 v180, v180
v_exp_f32 v181, v181
v_exp_f32 v182, v182
v_exp_f32 v183, v183
v_exp_f32 v184, v184
v_exp_f32 v185, v185
v_exp_f32 v186, v186
v_exp_f32 v187, v187
s_nop 0
v_cvt_pk_bf16_f32 v220, v172, v173
v_cvt_pk_bf16_f32 v221, v174, v175
v_cvt_pk_bf16_f32 v222, v176, v177
v_cvt_pk_bf16_f32 v223, v178, v179
v_cvt_pk_bf16_f32 v224, v180, v181
v_cvt_pk_bf16_f32 v225, v182, v183
v_cvt_pk_bf16_f32 v226, v184, v185
v_cvt_pk_bf16_f32 v227, v186, v187
s_nop 1
s_waitcnt lgkmcnt(10)
v_mfma_f32_32x32x16_bf16 v[204:219], v[60:63], v[220:223], v[204:219]
v_mfma_f32_32x32x16_bf16 v[204:219], v[64:67], v[224:227], v[204:219]
L_skip2_37:
s_cmp_gt_u32 s30, 3
s_cbranch_scc1 L_skip2_38
v_mfma_f32_32x32x16_bf16 v[156:171], v[20:23], v[244:247], v[188:203]
s_nop 15
v_exp_f32 v156, v156
v_exp_f32 v157, v157
v_exp_f32 v158, v158
v_exp_f32 v159, v159
v_exp_f32 v160, v160
v_exp_f32 v161, v161
v_exp_f32 v162, v162
v_exp_f32 v163, v163
v_exp_f32 v164, v164
v_exp_f32 v165, v165
v_exp_f32 v166, v166
v_exp_f32 v167, v167
v_exp_f32 v168, v168
v_exp_f32 v169, v169
v_exp_f32 v170, v170
v_exp_f32 v171, v171
s_nop 0
v_cvt_pk_bf16_f32 v228, v156, v157
v_cvt_pk_bf16_f32 v229, v158, v159
v_cvt_pk_bf16_f32 v230, v160, v161
v_cvt_pk_bf16_f32 v231, v162, v163
v_cvt_pk_bf16_f32 v232, v164, v165
v_cvt_pk_bf16_f32 v233, v166, v167
v_cvt_pk_bf16_f32 v234, v168, v169
v_cvt_pk_bf16_f32 v235, v170, v171
s_nop 1
s_waitcnt lgkmcnt(8)
v_mfma_f32_32x32x16_bf16 v[204:219], v[68:71], v[228:231], v[204:219]
v_mfma_f32_32x32x16_bf16 v[204:219], v[72:75], v[232:235], v[204:219]
L_skip2_38:
s_cmp_gt_u32 s30, 4
s_cbranch_scc1 L_skip2_39
v_mfma_f32_32x32x16_bf16 v[172:187], v[24:27], v[244:247], v[188:203]
s_nop 15
v_exp_f32 v172, v172
v_exp_f32 v173, v173
v_exp_f32 v174, v174
v_exp_f32 v175, v175
v_exp_f32 v176, v176
v_exp_f32 v177, v177
v_exp_f32 v178, v178
v_exp_f32 v179, v179
v_exp_f32 v180, v180
v_exp_f32 v181, v181
v_exp_f32 v182, v182
v_exp_f32 v183, v183
v_exp_f32 v184, v184
v_exp_f32 v185, v185
v_exp_f32 v186, v186
v_exp_f32 v187, v187
s_nop 0
v_cvt_pk_bf16_f32 v220, v172, v173
v_cvt_pk_bf16_f32 v221, v174, v175
v_cvt_pk_bf16_f32 v222, v176, v177
v_cvt_pk_bf16_f32 v223, v178, v179
v_cvt_pk_bf16_f32 v224, v180, v181
v_cvt_pk_bf16_f32 v225, v182, v183
v_cvt_pk_bf16_f32 v226, v184, v185
v_cvt_pk_bf16_f32 v227, v186, v187
s_nop 1
s_waitcnt lgkmcnt(6)
v_mfma_f32_32x32x16_bf16 v[204:219], v[76:79], v[220:223], v[204:219]
v_mfma_f32_32x32x16_bf16 v[204:219], v[80:83], v[224:227], v[204:219]
L_skip2_39:
s_cmp_gt_u32 s30, 5
s_cbranch_scc1 L_skip2_40
v_mfma_f32_32x32x16_bf16 v[156:171], v[28:31], v[244:247], v[188:203]
s_nop 15
v_exp_f32 v156, v156
v_exp_f32 v157, v157
v_exp_f32 v158, v158
v_exp_f32 v159, v159
v_exp_f32 v160, v160
v_exp_f32 v161, v161
v_exp_f32 v162, v162
v_exp_f32 v163, v163
v_exp_f32 v164, v164
v_exp_f32 v165, v165
v_exp_f32 v166, v166
v_exp_f32 v167, v167
v_exp_f32 v168, v168
v_exp_f32 v169, v169
v_exp_f32 v170, v170
v_exp_f32 v171, v171
s_nop 0
v_cvt_pk_bf16_f32 v228, v156, v157
v_cvt_pk_bf16_f32 v229, v158, v159
v_cvt_pk_bf16_f32 v230, v160, v161
v_cvt_pk_bf16_f32 v231, v162, v163
v_cvt_pk_bf16_f32 v232, v164, v165
v_cvt_pk_bf16_f32 v233, v166, v167
v_cvt_pk_bf16_f32 v234, v168, v169
v_cvt_pk_bf16_f32 v235, v170, v171
s_nop 1
s_waitcnt lgkmcnt(4)
v_mfma_f32_32x32x16_bf16 v[204:219], v[84:87], v[228:231], v[204:219]
v_mfma_f32_32x32x16_bf16 v[204:219], v[88:91], v[232:235], v[204:219]
L_skip2_40:
s_cmp_gt_u32 s30, 6
s_cbranch_scc1 L_skip2_41
v_mfma_f32_32x32x16_bf16 v[172:187], v[32:35], v[244:247], v[188:203]
s_nop 15
v_exp_f32 v172, v172
v_exp_f32 v173, v173
v_exp_f32 v174, v174
v_exp_f32 v175, v175
v_exp_f32 v176, v176
v_exp_f32 v177, v177
v_exp_f32 v178, v178
v_exp_f32 v179, v179
v_exp_f32 v180, v180
v_exp_f32 v181, v181
v_exp_f32 v182, v182
v_exp_f32 v183, v183
v_exp_f32 v184, v184
v_exp_f32 v185, v185
v_exp_f32 v186, v186
v_exp_f32 v187, v187
s_nop 0
v_cvt_pk_bf16_f32 v220, v172, v173
v_cvt_pk_bf16_f32 v221, v174, v175
v_cvt_pk_bf16_f32 v222, v176, v177
v_cvt_pk_bf16_f32 v223, v178, v179
v_cvt_pk_bf16_f32 v224, v180, v181
v_cvt_pk_bf16_f32 v225, v182, v183
v_cvt_pk_bf16_f32 v226, v184, v185
v_cvt_pk_bf16_f32 v227, v186, v187
s_nop 1
s_waitcnt lgkmcnt(2)
v_mfma_f32_32x32x16_bf16 v[204:219], v[92:95], v[220:223], v[204:219]
v_mfma_f32_32x32x16_bf16 v[204:219], v[96:99], v[224:227], v[204:219]
L_skip2_41:
s_cmp_gt_u32 s30, 7
s_cbranch_scc1 L_skip2_42
v_mfma_f32_32x32x16_bf16 v[156:171], v[36:39], v[244:247], v[188:203]
s_nop 15
v_exp_f32 v156, v156
v_exp_f32 v157, v157
v_exp_f32 v158, v158
v_exp_f32 v159, v159
v_exp_f32 v160, v160
v_exp_f32 v161, v161
v_exp_f32 v162, v162
v_exp_f32 v163, v163
v_exp_f32 v164, v164
v_exp_f32 v165, v165
v_exp_f32 v166, v166
v_exp_f32 v167, v167
v_exp_f32 v168, v168
v_exp_f32 v169, v169
v_exp_f32 v170, v170
v_exp_f32 v171, v171
s_nop 0
v_cvt_pk_bf16_f32 v228, v156, v157
v_cvt_pk_bf16_f32 v229, v158, v159
v_cvt_pk_bf16_f32 v230, v160, v161
v_cvt_pk_bf16_f32 v231, v162, v163
v_cvt_pk_bf16_f32 v232, v164, v165
v_cvt_pk_bf16_f32 v233, v166, v167
v_cvt_pk_bf16_f32 v234, v168, v169
v_cvt_pk_bf16_f32 v235, v170, v171
s_nop 1
s_waitcnt lgkmcnt(0)
v_mfma_f32_32x32x16_bf16 v[204:219], v[100:103], v[228:231], v[204:219]
v_mfma_f32_32x32x16_bf16 v[204:219], v[104:107], v[232:235], v[204:219]
L_skip2_42:
L_p2join_22:
s_nop 15
v_rcp_f32 v243, v212
s_nop 0
v_mul_f32 v204, v204, v243
v_mul_f32 v205, v205, v243
v_mul_f32 v206, v206, v243
v_mul_f32 v207, v207, v243
v_mul_f32 v208, v208, v243
v_mul_f32 v209, v209, v243
v_mul_f32 v210, v210, v243
v_mul_f32 v211, v211, v243
v_cvt_pk_bf16_f32 v220, v204, v205
v_cvt_pk_bf16_f32 v221, v206, v207
v_cvt_pk_bf16_f32 v222, v208, v209
v_cvt_pk_bf16_f32 v223, v210, v211
s_add_u32 s32, s31, 6291456
buffer_store_dwordx4 v[220:223], v236, s[8:11], s32 offen sc1
s_cmp_ge_u32 s5, 3
s_cbranch_scc1 L_w1e_43
s_mov_b32 s20, s72
s_mov_b32 s21, s73
s_mov_b32 s22, 1409024
s_mov_b32 s23, 0x20000
v_add_u32 v140, 0, v1
v_mul_u32_u24 v141, 171, v140
v_lshrrev_b32 v141, 11, v141
v_mul_u32_u24 v142, 12, v141
v_sub_u32 v140, v140, v142
v_lshlrev_b32 v140, 4, v140
v_mul_u32_u24 v141, 2752, v141
v_add_u32 v2, v140, v141
v_add_u32 v140, 64, v1
v_mul_u32_u24 v141, 171, v140
v_lshrrev_b32 v141, 11, v141
v_mul_u32_u24 v142, 12, v141
v_sub_u32 v140, v140, v142
v_lshlrev_b32 v140, 4, v140
v_mul_u32_u24 v141, 2752, v141
v_add_u32 v6, v140, v141
v_add_u32 v140, 128, v1
v_mul_u32_u24 v141, 171, v140
v_lshrrev_b32 v141, 11, v141
v_mul_u32_u24 v142, 12, v141
v_sub_u32 v140, v140, v142
v_lshlrev_b32 v140, 4, v140
v_mul_u32_u24 v141, 2752, v141
v_add_u32 v7, v140, v141
s_and_b32 s48, s3, 1
s_lshl_b32 s48, s48, 3
s_add_u32 s48, s48, s4
s_mul_i32 s48, s48, 192
s_mul_i32 s49, s5, 176128
s_add_u32 s48, s48, s49
s_mul_i32 s49, s5, 12288
s_add_u32 m0, s49, 65536
s_add_u32 s47, s48, 0
buffer_load_dwordx4 v2, s[20:23], s47 offen lds
s_add_u32 m0, s49, 66560
s_add_u32 s47, s48, 0
buffer_load_dwordx4 v6, s[20:23], s47 offen lds
s_add_u32 m0, s49, 67584
s_add_u32 s47, s48, 0
buffer_load_dwordx4 v7, s[20:23], s47 offen lds
s_add_u32 m0, s49, 68608
s_add_u32 s47, s48, 44032
buffer_load_dwordx4 v2, s[20:23], s47 offen lds
s_add_u32 m0, s49, 69632
s_add_u32 s47, s48, 44032
buffer_load_dwordx4 v6, s[20:23], s47 offen lds
s_add_u32 m0, s49, 70656
s_add_u32 s47, s48, 44032
buffer_load_dwordx4 v7, s[20:23], s47 offen lds
s_add_u32 m0, s49, 71680
s_add_u32 s47, s48, 88064
buffer_load_dwordx4 v2, s[20:23], s47 offen lds
s_add_u32 m0, s49, 72704
s_add_u32 s47, s48, 88064
buffer_load_dwordx4 v6, s[20:23], s47 offen lds
s_add_u32 m0, s49, 73728
s_add_u32 s47, s48, 88064
buffer_load_dwordx4 v7, s[20:23], s47 offen lds
s_add_u32 m0, s49, 74752
s_add_u32 s47, s48, 132096
buffer_load_dwordx4 v2, s[20:23], s47 offen lds
s_add_u32 m0, s49, 75776
s_add_u32 s47, s48, 132096
buffer_load_dwordx4 v6, s[20:23], s47 offen lds
s_add_u32 m0, s49, 76800
s_add_u32 s47, s48, 132096
buffer_load_dwordx4 v7, s[20:23], s47 offen lds
s_waitcnt vmcnt(12)
s_branch L_w1x_44
L_w1e_43:
s_waitcnt vmcnt(0)
L_w1x_44:
s_barrier
s_cmp_lg_u32 s5, 0
s_cbranch_scc1 L_nf_45
s_lshl_b32 s62, s3, 7
s_lshl_b32 s6, s4, 2
s_add_u32 s62, s62, s6
s_add_u32 s62, s62, 16781312
s_mov_b64 exec, 1
v_mov_b32 v254, s60
buffer_store_dword v254, off, s[8:11], s62 sc1
s_mov_b64 exec, -1
L_nf_45:
s_and_b32 s26, s5, 1
s_lshr_b32 s27, s5, 1
s_lshl_b32 s28, s3, 1
s_add_u32 s28, s28, s26
s_mov_b32 s16, s64
s_mov_b32 s17, s65
s_mov_b32 s18, 2097152
s_mov_b32 s19, 0x20000
s_lshl_b32 s29, s27, 3
v_lshlrev_b32 v8, 4, v1
s_mul_i32 s34, s28, 32
s_add_u32 s34, s34, s29
s_lshl_b32 s34, s34, 10
s_add_u32 s34, s34, 6291456
v_lshrrev_b32 v15, 5, v1
v_and_b32 v16, 31, v1
v_lshlrev_b32 v17, 10, v16
v_lshlrev_b32 v18, 3, v15
v_add_u32 v17, v17, v18
s_lshl_b32 s35, s28, 15
s_lshl_b32 s36, s4, 7
s_add_u32 s35, s35, s36
s_lshl_b32 s36, s27, 5
s_add_u32 s35, s35, s36
buffer_load_dwordx2 v[232:233], v17, s[16:19], s35 offen
buffer_load_dwordx2 v[234:235], v17, s[16:19], s35 offen offset:16
v_lshlrev_b32 v12, 9, v15
v_bfe_u32 v13, v1, 2, 2
v_lshlrev_b32 v13, 7, v13
v_add_u32 v12, v12, v13
v_bfe_u32 v13, v1, 3, 1
v_lshlrev_b32 v13, 6, v13
v_add_u32 v12, v12, v13
v_bfe_u32 v13, v1, 4, 1
v_lshlrev_b32 v13, 5, v13
v_add_u32 v12, v12, v13
v_and_b32 v13, 3, v1
v_lshlrev_b32 v13, 3, v13
v_add_u32 v12, v12, v13
s_lshl_b32 s36, s27, 11
v_add_u32 v2, s36, v12
v_xor_b32 v3, 64, v2
v_mov_b32 v160, 0
v_mov_b32 v161, 0
v_mov_b32 v162, 0
v_mov_b32 v163, 0
v_mov_b32 v164, 0
v_mov_b32 v165, 0
v_mov_b32 v166, 0
v_mov_b32 v167, 0
v_mov_b32 v168, 0
v_mov_b32 v169, 0
v_mov_b32 v170, 0
v_mov_b32 v171, 0
v_mov_b32 v172, 0
v_mov_b32 v173, 0
v_mov_b32 v174, 0
v_mov_b32 v175, 0
v_mov_b32 v176, 0
v_mov_b32 v177, 0
v_mov_b32 v178, 0
v_mov_b32 v179, 0
v_mov_b32 v180, 0
v_mov_b32 v181, 0
v_mov_b32 v182, 0
v_mov_b32 v183, 0
v_mov_b32 v184, 0
v_mov_b32 v185, 0
v_mov_b32 v186, 0
v_mov_b32 v187, 0
v_mov_b32 v188, 0
v_mov_b32 v189, 0
v_mov_b32 v190, 0
v_mov_b32 v191, 0
s_cmp_lt_u32 s5, 3
s_cbranch_scc1 L_w1l_50
s_mov_b32 s20, s72
s_mov_b32 s21, s73
s_mov_b32 s22, 1409024
s_mov_b32 s23, 0x20000
v_add_u32 v27, 0, v1
v_mul_u32_u24 v28, 171, v27
v_lshrrev_b32 v28, 11, v28
v_mul_u32_u24 v29, 12, v28
v_sub_u32 v27, v27, v29
v_lshlrev_b32 v27, 4, v27
v_mul_u32_u24 v28, 2752, v28
v_add_u32 v24, v27, v28
v_add_u32 v27, 64, v1
v_mul_u32_u24 v28, 171, v27
v_lshrrev_b32 v28, 11, v28
v_mul_u32_u24 v29, 12, v28
v_sub_u32 v27, v27, v29
v_lshlrev_b32 v27, 4, v27
v_mul_u32_u24 v28, 2752, v28
v_add_u32 v25, v27, v28
v_add_u32 v27, 128, v1
v_mul_u32_u24 v28, 171, v27
v_lshrrev_b32 v28, 11, v28
v_mul_u32_u24 v29, 12, v28
v_sub_u32 v27, v27, v29
v_lshlrev_b32 v27, 4, v27
v_mul_u32_u24 v28, 2752, v28
v_add_u32 v26, v27, v28
s_and_b32 s48, s3, 1
s_lshl_b32 s48, s48, 3
s_add_u32 s48, s48, s4
s_mul_i32 s48, s48, 192
s_mul_i32 s49, s5, 176128
s_add_u32 s48, s48, s49
s_mul_i32 s49, s5, 12288
s_add_u32 m0, s49, 65536
s_add_u32 s47, s48, 0
buffer_load_dwordx4 v24, s[20:23], s47 offen lds
s_add_u32 m0, s49, 66560
s_add_u32 s47, s48, 0
buffer_load_dwordx4 v25, s[20:23], s47 offen lds
s_add_u32 m0, s49, 67584
s_add_u32 s47, s48, 0
buffer_load_dwordx4 v26, s[20:23], s47 offen lds
s_add_u32 m0, s49, 68608
s_add_u32 s47, s48, 44032
buffer_load_dwordx4 v24, s[20:23], s47 offen lds
s_add_u32 m0, s49, 69632
s_add_u32 s47, s48, 44032
buffer_load_dwordx4 v25, s[20:23], s47 offen lds
s_add_u32 m0, s49, 70656
s_add_u32 s47, s48, 44032
buffer_load_dwordx4 v26, s[20:23], s47 offen lds
s_add_u32 m0, s49, 71680
s_add_u32 s47, s48, 88064
buffer_load_dwordx4 v24, s[20:23], s47 offen lds
s_add_u32 m0, s49, 72704
s_add_u32 s47, s48, 88064
buffer_load_dwordx4 v25, s[20:23], s47 offen lds
s_add_u32 m0, s49, 73728
s_add_u32 s47, s48, 88064
buffer_load_dwordx4 v26, s[20:23], s47 offen lds
s_add_u32 m0, s49, 74752
s_add_u32 s47, s48, 132096
buffer_load_dwordx4 v24, s[20:23], s47 offen lds
s_add_u32 m0, s49, 75776
s_add_u32 s47, s48, 132096
buffer_load_dwordx4 v25, s[20:23], s47 offen lds
s_add_u32 m0, s49, 76800
s_add_u32 s47, s48, 132096
buffer_load_dwordx4 v26, s[20:23], s47 offen lds
L_w1l_50:
s_cmp_lg_u32 s5, 0
s_cbranch_scc1 L_po_46
v_lshlrev_b32 v253, 2, v1
s_lshl_b32 s62, s3, 7
s_add_u32 s62, s62, 16781312
s_mov_b64 s[6:7], 0xff
s_cmp_eq_u64 s[6:7], 0
s_cbranch_scc1 L_pd_49
s_mov_b64 exec, s[6:7]
s_mov_b32 s61, 400015
s_add_u32 s56, s84, s62
s_addc_u32 s57, s85, 0
L_pl_48:
s_load_dwordx8 s[88:95], s[56:57], 0 glc
s_waitcnt lgkmcnt(0)
s_xor_b64 s[88:89], s[88:89], s[100:101]
s_xor_b64 s[90:91], s[90:91], s[100:101]
s_xor_b64 s[92:93], s[92:93], s[100:101]
s_xor_b64 s[94:95], s[94:95], s[100:101]
s_or_b64 s[88:89], s[88:89], s[90:91]
s_or_b64 s[92:93], s[92:93], s[94:95]
s_or_b64 s[52:53], s[88:89], s[92:93]
s_cmp_eq_u64 s[52:53], 0
s_cbranch_scc1 L_pd_49
s_and_b32 s58, s61, 15
s_cbranch_scc1 L_pv_51
buffer_load_dword v254, v253, s[8:11], s62 offen sc1
s_waitcnt vmcnt(0)
v_cmp_ne_u32 vcc, s60, v254
s_cbranch_vccz L_pd_49
L_pv_51:
s_sub_u32 s61, s61, 1
s_cbranch_scc0 L_pl_48
L_pd_49:
s_mov_b64 exec, -1
L_po_46:
s_barrier
buffer_load_dwordx4 v[64:67], v8, s[8:11], s34 offen offset:0 sc1
buffer_load_dwordx4 v[68:71], v8, s[8:11], s34 offen offset:1024 sc1
buffer_load_dwordx4 v[72:75], v8, s[8:11], s34 offen offset:2048 sc1
buffer_load_dwordx4 v[76:79], v8, s[8:11], s34 offen offset:3072 sc1
s_add_u32 s34, s34, 4096
buffer_load_dwordx4 v[80:83], v8, s[8:11], s34 offen offset:0 sc1
buffer_load_dwordx4 v[84:87], v8, s[8:11], s34 offen offset:1024 sc1
buffer_load_dwordx4 v[88:91], v8, s[8:11], s34 offen offset:2048 sc1
buffer_load_dwordx4 v[92:95], v8, s[8:11], s34 offen offset:3072 sc1
s_add_u32 s34, s34, 4096
ds_read_b64_tr_b16 v[192:193], v2 offset:0
ds_read_b64_tr_b16 v[194:195], v2 offset:1024
ds_read_b64_tr_b16 v[196:197], v3 offset:0
ds_read_b64_tr_b16 v[198:199], v3 offset:1024
ds_read_b64_tr_b16 v[200:201], v2 offset:8192
ds_read_b64_tr_b16 v[202:203], v2 offset:9216
ds_read_b64_tr_b16 v[204:205], v3 offset:8192
ds_read_b64_tr_b16 v[206:207], v3 offset:9216
s_waitcnt vmcnt(7) lgkmcnt(4)
v_mfma_f32_32x32x16_bf16 v[160:175], v[192:195], v[64:67], v[160:175]
v_mfma_f32_32x32x16_bf16 v[176:191], v[196:199], v[64:67], v[176:191]
ds_read_b64_tr_b16 v[192:193], v2 offset:16384
ds_read_b64_tr_b16 v[194:195], v2 offset:17408
ds_read_b64_tr_b16 v[196:197], v3 offset:16384
ds_read_b64_tr_b16 v[198:199], v3 offset:17408
s_waitcnt vmcnt(6) lgkmcnt(4)
v_mfma_f32_32x32x16_bf16 v[160:175], v[200:203], v[68:71], v[160:175]
v_mfma_f32_32x32x16_bf16 v[176:191], v[204:207], v[68:71], v[176:191]
ds_read_b64_tr_b16 v[200:201], v2 offset:24576
ds_read_b64_tr_b16 v[202:203], v2 offset:25600
ds_read_b64_tr_b16 v[204:205], v3 offset:24576
ds_read_b64_tr_b16 v[206:207], v3 offset:25600
s_waitcnt vmcnt(5) lgkmcnt(4)
v_mfma_f32_32x32x16_bf16 v[160:175], v[192:195], v[72:75], v[160:175]
v_mfma_f32_32x32x16_bf16 v[176:191], v[196:199], v[72:75], v[176:191]
ds_read_b64_tr_b16 v[192:193], v2 offset:32768
ds_read_b64_tr_b16 v[194:195], v2 offset:33792
ds_read_b64_tr_b16 v[196:197], v3 offset:32768
ds_read_b64_tr_b16 v[198:199], v3 offset:33792
s_waitcnt vmcnt(4) lgkmcnt(4)
v_mfma_f32_32x32x16_bf16 v[160:175], v[200:203], v[76:79], v[160:175]
v_mfma_f32_32x32x16_bf16 v[176:191], v[204:207], v[76:79], v[176:191]
ds_read_b64_tr_b16 v[200:201], v2 offset:40960
ds_read_b64_tr_b16 v[202:203], v2 offset:41984
ds_read_b64_tr_b16 v[204:205], v3 offset:40960
ds_read_b64_tr_b16 v[206:207], v3 offset:41984
s_waitcnt vmcnt(3) lgkmcnt(4)
v_mfma_f32_32x32x16_bf16 v[160:175], v[192:195], v[80:83], v[160:175]
v_mfma_f32_32x32x16_bf16 v[176:191], v[196:199], v[80:83], v[176:191]
ds_read_b64_tr_b16 v[192:193], v2 offset:49152
ds_read_b64_tr_b16 v[194:195], v2 offset:50176
ds_read_b64_tr_b16 v[196:197], v3 offset:49152
ds_read_b64_tr_b16 v[198:199], v3 offset:50176
s_waitcnt vmcnt(2) lgkmcnt(4)
v_mfma_f32_32x32x16_bf16 v[160:175], v[200:203], v[84:87], v[160:175]
v_mfma_f32_32x32x16_bf16 v[176:191], v[204:207], v[84:87], v[176:191]
ds_read_b64_tr_b16 v[200:201], v2 offset:57344
ds_read_b64_tr_b16 v[202:203], v2 offset:58368
ds_read_b64_tr_b16 v[204:205], v3 offset:57344
ds_read_b64_tr_b16 v[206:207], v3 offset:58368
s_waitcnt vmcnt(1) lgkmcnt(4)
v_mfma_f32_32x32x16_bf16 v[160:175], v[192:195], v[88:91], v[160:175]
v_mfma_f32_32x32x16_bf16 v[176:191], v[196:199], v[88:91], v[176:191]
s_waitcnt vmcnt(0) lgkmcnt(0)
v_mfma_f32_32x32x16_bf16 v[160:175], v[200:203], v[92:95], v[160:175]
v_mfma_f32_32x32x16_bf16 v[176:191], v[204:207], v[92:95], v[176:191]
s_nop 15
s_barrier
s_lshl_b32 s36, s26, 15
s_lshl_b32 s37, s27, 11
s_add_u32 s36, s36, s37
v_add_u32 v9, s36, v8
ds_write_b128 v9, v[160:163] offset:0
ds_write_b128 v9, v[164:167] offset:1024
ds_write_b128 v9, v[168:171] offset:8192
ds_write_b128 v9, v[172:175] offset:9216
ds_write_b128 v9, v[176:179] offset:16384
ds_write_b128 v9, v[180:183] offset:17408
ds_write_b128 v9, v[184:187] offset:24576
ds_write_b128 v9, v[188:191] offset:25600
s_waitcnt vmcnt(0)
v_lshlrev_b32 v208, 16, v232
v_and_b32 v209, 0xffff0000, v232
v_lshlrev_b32 v210, 16, v233
v_and_b32 v211, 0xffff0000, v233
v_lshlrev_b32 v212, 16, v234
v_and_b32 v213, 0xffff0000, v234
v_lshlrev_b32 v214, 16, v235
v_and_b32 v215, 0xffff0000, v235
s_waitcnt lgkmcnt(0)
s_barrier
s_lshl_b32 s36, s26, 15
s_lshl_b32 s37, s27, 13
s_add_u32 s36, s36, s37
v_add_u32 v9, s36, v8
ds_read_b128 v[64:67], v9 offset:0
ds_read_b128 v[68:71], v9 offset:1024
ds_read_b128 v[72:75], v9 offset:2048
ds_read_b128 v[76:79], v9 offset:3072
ds_read_b128 v[80:83], v9 offset:4096
ds_read_b128 v[84:87], v9 offset:5120
ds_read_b128 v[88:91], v9 offset:6144
ds_read_b128 v[92:95], v9 offset:7168
s_waitcnt lgkmcnt(4)
v_add_f32 v64, v64, v72
v_add_f32 v64, v64, v208
v_add_f32 v65, v65, v73
v_add_f32 v65, v65, v209
v_add_f32 v66, v66, v74
v_add_f32 v66, v66, v210
v_add_f32 v67, v67, v75
v_add_f32 v67, v67, v211
v_add_f32 v68, v68, v76
v_add_f32 v68, v68, v212
v_add_f32 v69, v69, v77
v_add_f32 v69, v69, v213
v_add_f32 v70, v70, v78
v_add_f32 v70, v70, v214
v_add_f32 v71, v71, v79
v_add_f32 v71, v71, v215
s_waitcnt lgkmcnt(0)
v_add_f32 v80, v80, v88
v_add_f32 v64, v64, v80
v_add_f32 v81, v81, v89
v_add_f32 v65, v65, v81
v_add_f32 v82, v82, v90
v_add_f32 v66, v66, v82
v_add_f32 v83, v83, v91
v_add_f32 v67, v67, v83
v_add_f32 v84, v84, v92
v_add_f32 v68, v68, v84
v_add_f32 v85, v85, v93
v_add_f32 v69, v69, v85
v_add_f32 v86, v86, v94
v_add_f32 v70, v70, v86
v_add_f32 v87, v87, v95
v_add_f32 v71, v71, v87
v_cvt_pk_bf16_f32 v248, v64, v65
v_cvt_pk_bf16_f32 v249, v66, v67
v_cvt_pk_bf16_f32 v250, v68, v69
v_cvt_pk_bf16_f32 v251, v70, v71
s_lshl_b32 s35, s28, 5
s_lshl_b32 s36, s4, 2
s_add_u32 s35, s35, s36
s_add_u32 s35, s35, s27
s_lshl_b32 s35, s35, 10
s_add_u32 s35, s35, 8388608
buffer_store_dwordx4 v[248:251], v8, s[8:11], s35 offen sc1
v_mov_b32 v208, 0
v_mov_b32 v209, 0
s_mov_b32 s37, 0x3f803f80
v_dot2c_f32_bf16 v208, s37, v248
v_dot2c_f32_bf16 v209, v248, v248
v_dot2c_f32_bf16 v208, s37, v249
v_dot2c_f32_bf16 v209, v249, v249
v_dot2c_f32_bf16 v208, s37, v250
v_dot2c_f32_bf16 v209, v250, v250
v_dot2c_f32_bf16 v208, s37, v251
v_dot2c_f32_bf16 v209, v251, v251
s_nop 2
v_mov_b32 v210, v208
v_mov_b32 v211, v209
s_nop 1
v_permlane32_swap_b32 v208, v210
v_permlane32_swap_b32 v209, v211
s_nop 1
v_add_f32 v208, v208, v210
v_add_f32 v209, v209, v211
s_lshl_b32 s36, s26, 15
s_lshl_b32 s37, s27, 13
s_add_u32 s36, s36, s37
v_lshlrev_b32 v212, 3, v16
v_add_u32 v213, s36, v212
ds_write_b64 v213, v[208:209]
s_waitcnt lgkmcnt(0)
s_barrier
s_cmp_lg_u32 s27, 0
s_cbranch_scc1 L_nst_52
ds_read_b64 v[216:217], v213 offset:0
ds_read_b64 v[218:219], v213 offset:8192
ds_read_b64 v[220:221], v213 offset:16384
ds_read_b64 v[222:223], v213 offset:24576
s_lshl_b32 s36, s28, 3
s_add_u32 s36, s36, s4
s_lshl_b32 s36, s36, 8
s_add_u32 s36, s36, 0
s_waitcnt lgkmcnt(0)
v_add_f32 v216, v216, v218
v_add_f32 v217, v217, v219
v_add_f32 v220, v220, v222
v_add_f32 v221, v221, v223
v_add_f32 v216, v216, v220
v_add_f32 v217, v217, v221
s_mov_b64 exec, 0xffffffff
buffer_store_dwordx2 v[216:217], v212, s[8:11], s36 offen sc1
s_mov_b64 exec, -1
L_nst_52:
s_and_b32 s30, s5, 3
s_lshr_b32 s31, s5, 2
v_lshrrev_b32 v3, 5, v1
v_mul_u32_u24 v2, 768, v3
v_bfe_u32 v3, v1, 2, 2
v_mul_u32_u24 v3, 192, v3
v_add_u32 v2, v2, v3
v_bfe_u32 v3, v1, 4, 1
v_lshlrev_b32 v3, 5, v3
v_add_u32 v2, v2, v3
v_and_b32 v3, 3, v1
v_lshlrev_b32 v3, 3, v3
v_add_u32 v2, v2, v3
s_mul_i32 s32, s31, 49152
s_mul_i32 s33, s30, 3072
s_add_u32 s32, s32, s33
s_add_u32 s32, s32, 65536
v_add_u32 v2, s32, v2
v_mov_b32 v18, 0
v_mov_b32 v19, 0
v_mov_b32 v20, 0
s_mov_b32 s33, 0x3f803f80
ds_read_b64_tr_b16 v[176:177], v2 offset:0
ds_read_b64_tr_b16 v[178:179], v2 offset:1536
ds_read_b64_tr_b16 v[180:181], v2 offset:64
ds_read_b64_tr_b16 v[182:183], v2 offset:1600
ds_read_b64_tr_b16 v[184:185], v2 offset:128
ds_read_b64_tr_b16 v[186:187], v2 offset:1664
ds_read_b64_tr_b16 v[188:189], v2 offset:12288
ds_read_b64_tr_b16 v[190:191], v2 offset:13824
ds_read_b64_tr_b16 v[192:193], v2 offset:12352
ds_read_b64_tr_b16 v[194:195], v2 offset:13888
ds_read_b64_tr_b16 v[196:197], v2 offset:12416
ds_read_b64_tr_b16 v[198:199], v2 offset:13952
s_waitcnt lgkmcnt(6)
v_dot2c_f32_bf16 v18, s33, v176
v_dot2c_f32_bf16 v18, s33, v177
v_dot2c_f32_bf16 v18, s33, v178
v_dot2c_f32_bf16 v18, s33, v179
v_dot2c_f32_bf16 v19, s33, v180
v_dot2c_f32_bf16 v19, s33, v181
v_dot2c_f32_bf16 v19, s33, v182
v_dot2c_f32_bf16 v19, s33, v183
v_dot2c_f32_bf16 v20, s33, v184
v_dot2c_f32_bf16 v20, s33, v185
v_dot2c_f32_bf16 v20, s33, v186
v_dot2c_f32_bf16 v20, s33, v187
s_waitcnt lgkmcnt(0)
v_dot2c_f32_bf16 v18, s33, v188
v_dot2c_f32_bf16 v18, s33, v189
v_dot2c_f32_bf16 v18, s33, v190
v_dot2c_f32_bf16 v18, s33, v191
v_dot2c_f32_bf16 v19, s33, v192
v_dot2c_f32_bf16 v19, s33, v193
v_dot2c_f32_bf16 v19, s33, v194
v_dot2c_f32_bf16 v19, s33, v195
v_dot2c_f32_bf16 v20, s33, v196
v_dot2c_f32_bf16 v20, s33, v197
v_dot2c_f32_bf16 v20, s33, v198
v_dot2c_f32_bf16 v20, s33, v199
ds_read_b64_tr_b16 v[176:177], v2 offset:24576
ds_read_b64_tr_b16 v[178:179], v2 offset:26112
ds_read_b64_tr_b16 v[180:181], v2 offset:24640
ds_read_b64_tr_b16 v[182:183], v2 offset:26176
ds_read_b64_tr_b16 v[184:185], v2 offset:24704
ds_read_b64_tr_b16 v[186:187], v2 offset:26240
ds_read_b64_tr_b16 v[188:189], v2 offset:36864
ds_read_b64_tr_b16 v[190:191], v2 offset:38400
ds_read_b64_tr_b16 v[192:193], v2 offset:36928
ds_read_b64_tr_b16 v[194:195], v2 offset:38464
ds_read_b64_tr_b16 v[196:197], v2 offset:36992
ds_read_b64_tr_b16 v[198:199], v2 offset:38528
s_waitcnt lgkmcnt(6)
v_dot2c_f32_bf16 v18, s33, v176
v_dot2c_f32_bf16 v18, s33, v177
v_dot2c_f32_bf16 v18, s33, v178
v_dot2c_f32_bf16 v18, s33, v179
v_dot2c_f32_bf16 v19, s33, v180
v_dot2c_f32_bf16 v19, s33, v181
v_dot2c_f32_bf16 v19, s33, v182
v_dot2c_f32_bf16 v19, s33, v183
v_dot2c_f32_bf16 v20, s33, v184
v_dot2c_f32_bf16 v20, s33, v185
v_dot2c_f32_bf16 v20, s33, v186
v_dot2c_f32_bf16 v20, s33, v187
s_waitcnt lgkmcnt(0)
v_dot2c_f32_bf16 v18, s33, v188
v_dot2c_f32_bf16 v18, s33, v189
v_dot2c_f32_bf16 v18, s33, v190
v_dot2c_f32_bf16 v18, s33, v191
v_dot2c_f32_bf16 v19, s33, v192
v_dot2c_f32_bf16 v19, s33, v193
v_dot2c_f32_bf16 v19, s33, v194
v_dot2c_f32_bf16 v19, s33, v195
v_dot2c_f32_bf16 v20, s33, v196
v_dot2c_f32_bf16 v20, s33, v197
v_dot2c_f32_bf16 v20, s33, v198
v_dot2c_f32_bf16 v20, s33, v199
v_lshlrev_b32 v3, 2, v1
s_mul_i32 s32, s5, 768
v_add_u32 v3, s32, v3
s_nop 2
ds_write_b32 v3, v18 offset:1024
ds_write_b32 v3, v19 offset:1280
ds_write_b32 v3, v20 offset:1536
s_waitcnt lgkmcnt(0)
s_waitcnt vmcnt(0)
s_barrier
s_cmp_lg_u32 s5, 0
s_cbranch_scc1 L_nf_53
s_lshl_b32 s62, s3, 7
s_lshl_b32 s6, s4, 2
s_add_u32 s62, s62, s6
s_add_u32 s62, s62, 16785408
s_mov_b64 exec, 1
v_mov_b32 v254, s60
buffer_store_dword v254, off, s[8:11], s62 sc1
s_mov_b64 exec, -1
L_nf_53:
s_lshr_b32 s24, s3, 1
s_and_b32 s25, s3, 1
s_lshl_b32 s25, s25, 3
s_add_u32 s25, s25, s4
s_and_b32 s26, s5, 3
s_lshr_b32 s27, s5, 2
s_lshl_b32 s28, s24, 2
s_add_u32 s28, s28, s26
s_mov_b32 s20, s74
s_mov_b32 s21, s75
s_mov_b32 s22, 2752
s_mov_b32 s23, 0x20000
s_mov_b32 s12, s76
s_mov_b32 s13, s77
s_mov_b32 s14, 1409024
s_mov_b32 s15, 0x20000
v_lshrrev_b32 v21, 3, v1
v_mul_u32_u24 v21, 1024, v21
v_bfe_u32 v4, v1, 4, 1
v_lshlrev_b32 v4, 2, v4
v_xor_b32 v4, v4, v1
v_and_b32 v4, 7, v4
v_lshlrev_b32 v4, 4, v4
v_add_u32 v21, v21, v4
s_lshr_b32 s46, s5, 1
s_mul_i32 s44, s46, 22
s_cmp_eq_u32 s46, 3
s_cselect_b32 s47, 1, 0
s_sub_u32 s44, s44, s47
s_lshl_b32 s44, s44, 14
s_and_b32 s47, s5, 1
s_lshl_b32 s45, s47, 13
s_add_u32 s44, s44, s45
s_lshl_b32 s45, s4, 7
s_add_u32 s44, s44, s45
s_lshl_b32 s45, s46, 11
s_lshl_b32 s47, s47, 10
s_add_u32 s45, s45, s47
v_lshlrev_b32 v4, 4, v1
s_lshl_b32 s29, s28, 5
s_lshl_b32 s30, s27, 4
s_add_u32 s29, s29, s30
s_lshl_b32 s29, s29, 10
s_add_u32 s29, s29, 8388608
v_lshrrev_b32 v11, 5, v1
v_lshlrev_b32 v14, 3, v11
s_mul_i32 s40, s25, 192
s_lshl_b32 s41, s27, 6
s_add_u32 s41, s41, s40
buffer_load_dwordx2 v[36:37], v14, s[20:23], s41 offen offset:0
buffer_load_dwordx2 v[38:39], v14, s[20:23], s41 offen offset:16
buffer_load_dwordx2 v[40:41], v14, s[20:23], s41 offen offset:32
buffer_load_dwordx2 v[42:43], v14, s[20:23], s41 offen offset:48
s_lshl_b32 s41, s27, 5
s_add_u32 s41, s41, s40
s_add_u32 s41, s41, 128
buffer_load_dwordx2 v[44:45], v14, s[20:23], s41 offen offset:0
buffer_load_dwordx2 v[46:47], v14, s[20:23], s41 offen offset:16
v_mul_u32_u24 v8, 768, v11
v_bfe_u32 v9, v1, 2, 2
v_mul_u32_u24 v9, 192, v9
v_add_u32 v8, v8, v9
v_bfe_u32 v9, v1, 4, 1
v_lshlrev_b32 v9, 5, v9
v_add_u32 v8, v8, v9
v_and_b32 v9, 3, v1
v_lshlrev_b32 v9, 3, v9
v_add_u32 v8, v8, v9
s_mul_i32 s36, s27, 49152
s_add_u32 s36, s36, 65536
v_add_u32 v2, s36, v8
v_mov_b32 v128, 0
v_mov_b32 v129, 0
v_mov_b32 v130, 0
v_mov_b32 v131, 0
v_mov_b32 v132, 0
v_mov_b32 v133, 0
v_mov_b32 v134, 0
v_mov_b32 v135, 0
v_mov_b32 v136, 0
v_mov_b32 v137, 0
v_mov_b32 v138, 0
v_mov_b32 v139, 0
v_mov_b32 v140, 0
v_mov_b32 v141, 0
v_mov_b32 v142, 0
v_mov_b32 v143, 0
v_mov_b32 v144, 0
v_mov_b32 v145, 0
v_mov_b32 v146, 0
v_mov_b32 v147, 0
v_mov_b32 v148, 0
v_mov_b32 v149, 0
v_mov_b32 v150, 0
v_mov_b32 v151, 0
v_mov_b32 v152, 0
v_mov_b32 v153, 0
v_mov_b32 v154, 0
v_mov_b32 v155, 0
v_mov_b32 v156, 0
v_mov_b32 v157, 0
v_mov_b32 v158, 0
v_mov_b32 v159, 0
v_mov_b32 v160, 0
v_mov_b32 v161, 0
v_mov_b32 v162, 0
v_mov_b32 v163, 0
v_mov_b32 v164, 0
v_mov_b32 v165, 0
v_mov_b32 v166, 0
v_mov_b32 v167, 0
v_mov_b32 v168, 0
v_mov_b32 v169, 0
v_mov_b32 v170, 0
v_mov_b32 v171, 0
v_mov_b32 v172, 0
v_mov_b32 v173, 0
v_mov_b32 v174, 0
v_mov_b32 v175, 0
v_mov_b32 v16, 0
v_mov_b32 v17, 0
v_mov_b32 v18, 0
v_mov_b32 v19, 0
v_mov_b32 v20, 0
s_mov_b32 s37, 0x3f803f80
s_mul_i32 s38, s26, 3072
v_add_u32 v12, s38, v2
s_cmp_eq_u32 s25, 15
s_cbranch_scc1 L_p4idle_55
v_lshlrev_b32 v7, 2, v1
s_lshl_b32 s38, s27, 8
v_add_u32 v8, s38, v7
ds_read_b32 v64, v8 offset:1024
ds_read_b32 v65, v8 offset:1792
ds_read_b32 v66, v8 offset:2560
ds_read_b32 v67, v8 offset:3328
ds_read_b32 v68, v8 offset:4096
ds_read_b32 v69, v8 offset:4864
ds_read_b32 v70, v8 offset:5632
ds_read_b32 v71, v8 offset:6400
s_waitcnt lgkmcnt(0)
ds_read_b32 v72, v7 offset:1536
ds_read_b32 v73, v7 offset:2304
ds_read_b32 v74, v7 offset:3072
ds_read_b32 v75, v7 offset:3840
ds_read_b32 v76, v7 offset:4608
ds_read_b32 v77, v7 offset:5376
ds_read_b32 v78, v7 offset:6144
ds_read_b32 v79, v7 offset:6912
v_add_f32 v64, v64, v65
v_add_f32 v64, v64, v66
v_add_f32 v64, v64, v67
v_add_f32 v64, v64, v68
v_add_f32 v64, v64, v69
v_add_f32 v64, v64, v70
v_add_f32 v64, v64, v71
v_mov_b32 v65, v64
s_waitcnt lgkmcnt(0)
v_add_f32 v72, v72, v73
v_add_f32 v72, v72, v74
v_add_f32 v72, v72, v75
v_add_f32 v72, v72, v76
v_add_f32 v72, v72, v77
v_add_f32 v72, v72, v78
v_add_f32 v72, v72, v79
v_mov_b32 v73, v72
s_nop 1
v_permlane32_swap_b32 v64, v65
v_permlane32_swap_b32 v72, v73
s_nop 1
v_add_f32 v64, v64, v65
v_add_f32 v72, v72, v73
v_and_b32 v9, 31, v1
s_lshl_b32 s38, s5, 9
v_lshlrev_b32 v10, 2, v9
v_add_u32 v10, s38, v10
ds_write_b32 v10, v64 offset:8448
ds_write_b32 v10, v72 offset:8576
v_lshlrev_b32 v12, 4, v11
v_add_u32 v12, s38, v12
s_lshl_b32 s39, s27, 6
v_add_u32 v13, s39, v12
s_waitcnt lgkmcnt(0)
ds_read_b128 v[232:235], v12 offset:8448
ds_read_b128 v[236:239], v12 offset:8480
ds_read_b128 v[240:243], v12 offset:8512
ds_read_b128 v[244:247], v12 offset:8544
ds_read_b128 v[48:51], v13 offset:8576
ds_read_b128 v[52:55], v13 offset:8608
s_waitcnt lgkmcnt(0)
s_cmp_lg_u32 s5, 0
s_cbranch_scc1 L_po_56
v_lshrrev_b32 v253, 3, v1
v_lshlrev_b32 v253, 7, v253
v_and_b32 v254, 7, v1
v_lshlrev_b32 v254, 2, v254
v_add_u32 v253, v253, v254
s_lshl_b32 s62, s24, 8
s_add_u32 s62, s62, 16785408
s_mov_b64 s[6:7], 0xffff
s_cmp_eq_u64 s[6:7], 0
s_cbranch_scc1 L_pd_59
s_mov_b64 exec, s[6:7]
s_mov_b32 s61, 400015
s_add_u32 s56, s84, s62
s_addc_u32 s57, s85, 0
L_pl_58:
s_load_dwordx8 s[88:95], s[56:57], 0 glc
s_load_dwordx8 s[48:55], s[56:57], 128 glc
s_waitcnt lgkmcnt(0)
s_xor_b64 s[88:89], s[88:89], s[100:101]
s_xor_b64 s[90:91], s[90:91], s[100:101]
s_xor_b64 s[92:93], s[92:93], s[100:101]
s_xor_b64 s[94:95], s[94:95], s[100:101]
s_xor_b64 s[48:49], s[48:49], s[100:101]
s_xor_b64 s[50:51], s[50:51], s[100:101]
s_xor_b64 s[52:53], s[52:53], s[100:101]
s_xor_b64 s[54:55], s[54:55], s[100:101]
s_or_b64 s[88:89], s[88:89], s[48:49]
s_or_b64 s[90:91], s[90:91], s[50:51]
s_or_b64 s[92:93], s[92:93], s[52:53]
s_or_b64 s[94:95], s[94:95], s[54:55]
s_or_b64 s[88:89], s[88:89], s[90:91]
s_or_b64 s[92:93], s[92:93], s[94:95]
s_or_b64 s[52:53], s[88:89], s[92:93]
s_cmp_eq_u64 s[52:53], 0
s_cbranch_scc1 L_pd_59
s_and_b32 s58, s61, 15
s_cbranch_scc1 L_pv_60
buffer_load_dword v254, v253, s[8:11], s62 offen sc1
s_waitcnt vmcnt(0)
v_cmp_ne_u32 vcc, s60, v254
s_cbranch_vccz L_pd_59
L_pv_60:
s_sub_u32 s61, s61, 1
s_cbranch_scc0 L_pl_58
L_pd_59:
s_mov_b64 exec, -1
L_po_56:
s_barrier
buffer_load_dwordx4 v[64:67], v4, s[8:11], s29 offen offset:0 sc1
buffer_load_dwordx4 v[68:71], v4, s[8:11], s29 offen offset:1024 sc1
buffer_load_dwordx4 v[72:75], v4, s[8:11], s29 offen offset:2048 sc1
buffer_load_dwordx4 v[76:79], v4, s[8:11], s29 offen offset:3072 sc1
s_add_u32 s29, s29, 4096
v_and_b32 v9, 31, v1
v_lshlrev_b32 v9, 3, v9
v_lshlrev_b32 v10, 10, v11
v_add_u32 v9, v9, v10
s_lshl_b32 s30, s28, 11
s_add_u32 s30, s30, 0
buffer_load_dwordx2 v[24:25], v9, s[8:11], s30 offen offset:0 sc1
buffer_load_dwordx2 v[26:27], v9, s[8:11], s30 offen offset:256 sc1
buffer_load_dwordx2 v[28:29], v9, s[8:11], s30 offen offset:512 sc1
buffer_load_dwordx2 v[30:31], v9, s[8:11], s30 offen offset:768 sc1
ds_read_b64_tr_b16 v[176:177], v2 offset:0
ds_read_b64_tr_b16 v[178:179], v2 offset:1536
ds_read_b64_tr_b16 v[180:181], v2 offset:64
ds_read_b64_tr_b16 v[182:183], v2 offset:1600
ds_read_b64_tr_b16 v[184:185], v2 offset:128
ds_read_b64_tr_b16 v[186:187], v2 offset:1664
ds_read_b64_tr_b16 v[188:189], v2 offset:3072
ds_read_b64_tr_b16 v[190:191], v2 offset:4608
ds_read_b64_tr_b16 v[192:193], v2 offset:3136
ds_read_b64_tr_b16 v[194:195], v2 offset:4672
ds_read_b64_tr_b16 v[196:197], v2 offset:3200
ds_read_b64_tr_b16 v[198:199], v2 offset:4736
buffer_load_dwordx4 v[80:83], v4, s[8:11], s29 offen offset:0 sc1
s_waitcnt vmcnt(8) lgkmcnt(6)
v_mfma_f32_32x32x16_bf16 v[128:143], v[176:179], v[64:67], v[128:143]
v_mfma_f32_32x32x16_bf16 v[144:159], v[180:183], v[64:67], v[144:159]
v_mfma_f32_32x32x16_bf16 v[160:175], v[184:187], v[64:67], v[160:175]
ds_read_b64_tr_b16 v[176:177], v2 offset:6144
ds_read_b64_tr_b16 v[178:179], v2 offset:7680
ds_read_b64_tr_b16 v[180:181], v2 offset:6208
ds_read_b64_tr_b16 v[182:183], v2 offset:7744
ds_read_b64_tr_b16 v[184:185], v2 offset:6272
ds_read_b64_tr_b16 v[186:187], v2 offset:7808
buffer_load_dwordx4 v[84:87], v4, s[8:11], s29 offen offset:1024 sc1
s_waitcnt vmcnt(8) lgkmcnt(6)
v_mfma_f32_32x32x16_bf16 v[128:143], v[188:191], v[68:71], v[128:143]
v_mfma_f32_32x32x16_bf16 v[144:159], v[192:195], v[68:71], v[144:159]
v_mfma_f32_32x32x16_bf16 v[160:175], v[196:199], v[68:71], v[160:175]
ds_read_b64_tr_b16 v[188:189], v2 offset:9216
ds_read_b64_tr_b16 v[190:191], v2 offset:10752
ds_read_b64_tr_b16 v[192:193], v2 offset:9280
ds_read_b64_tr_b16 v[194:195], v2 offset:10816
ds_read_b64_tr_b16 v[196:197], v2 offset:9344
ds_read_b64_tr_b16 v[198:199], v2 offset:10880
buffer_load_dwordx4 v[88:91], v4, s[8:11], s29 offen offset:2048 sc1
s_waitcnt vmcnt(8) lgkmcnt(6)
v_mfma_f32_32x32x16_bf16 v[128:143], v[176:179], v[72:75], v[128:143]
v_mfma_f32_32x32x16_bf16 v[144:159], v[180:183], v[72:75], v[144:159]
v_mfma_f32_32x32x16_bf16 v[160:175], v[184:187], v[72:75], v[160:175]
ds_read_b64_tr_b16 v[176:177], v2 offset:12288
ds_read_b64_tr_b16 v[178:179], v2 offset:13824
ds_read_b64_tr_b16 v[180:181], v2 offset:12352
ds_read_b64_tr_b16 v[182:183], v2 offset:13888
ds_read_b64_tr_b16 v[184:185], v2 offset:12416
ds_read_b64_tr_b16 v[186:187], v2 offset:13952
buffer_load_dwordx4 v[92:95], v4, s[8:11], s29 offen offset:3072 sc1
s_add_u32 s29, s29, 4096
s_waitcnt vmcnt(8) lgkmcnt(6)
v_mfma_f32_32x32x16_bf16 v[128:143], v[188:191], v[76:79], v[128:143]
v_mfma_f32_32x32x16_bf16 v[144:159], v[192:195], v[76:79], v[144:159]
v_mfma_f32_32x32x16_bf16 v[160:175], v[196:199], v[76:79], v[160:175]
ds_read_b64_tr_b16 v[188:189], v2 offset:15360
ds_read_b64_tr_b16 v[190:191], v2 offset:16896
ds_read_b64_tr_b16 v[192:193], v2 offset:15424
ds_read_b64_tr_b16 v[194:195], v2 offset:16960
ds_read_b64_tr_b16 v[196:197], v2 offset:15488
ds_read_b64_tr_b16 v[198:199], v2 offset:17024
buffer_load_dwordx4 v[96:99], v4, s[8:11], s29 offen offset:0 sc1
s_waitcnt vmcnt(4) lgkmcnt(6)
v_mfma_f32_32x32x16_bf16 v[128:143], v[176:179], v[80:83], v[128:143]
v_mfma_f32_32x32x16_bf16 v[144:159], v[180:183], v[80:83], v[144:159]
v_mfma_f32_32x32x16_bf16 v[160:175], v[184:187], v[80:83], v[160:175]
ds_read_b64_tr_b16 v[176:177], v2 offset:18432
ds_read_b64_tr_b16 v[178:179], v2 offset:19968
ds_read_b64_tr_b16 v[180:181], v2 offset:18496
ds_read_b64_tr_b16 v[182:183], v2 offset:20032
ds_read_b64_tr_b16 v[184:185], v2 offset:18560
ds_read_b64_tr_b16 v[186:187], v2 offset:20096
buffer_load_dwordx4 v[100:103], v4, s[8:11], s29 offen offset:1024 sc1
s_waitcnt vmcnt(4) lgkmcnt(6)
v_mfma_f32_32x32x16_bf16 v[128:143], v[188:191], v[84:87], v[128:143]
v_mfma_f32_32x32x16_bf16 v[144:159], v[192:195], v[84:87], v[144:159]
v_mfma_f32_32x32x16_bf16 v[160:175], v[196:199], v[84:87], v[160:175]
ds_read_b64_tr_b16 v[188:189], v2 offset:21504
ds_read_b64_tr_b16 v[190:191], v2 offset:23040
ds_read_b64_tr_b16 v[192:193], v2 offset:21568
ds_read_b64_tr_b16 v[194:195], v2 offset:23104
ds_read_b64_tr_b16 v[196:197], v2 offset:21632
ds_read_b64_tr_b16 v[198:199], v2 offset:23168
buffer_load_dwordx4 v[104:107], v4, s[8:11], s29 offen offset:2048 sc1
s_waitcnt vmcnt(4) lgkmcnt(6)
v_mfma_f32_32x32x16_bf16 v[128:143], v[176:179], v[88:91], v[128:143]
v_mfma_f32_32x32x16_bf16 v[144:159], v[180:183], v[88:91], v[144:159]
v_mfma_f32_32x32x16_bf16 v[160:175], v[184:187], v[88:91], v[160:175]
ds_read_b64_tr_b16 v[176:177], v2 offset:24576
ds_read_b64_tr_b16 v[178:179], v2 offset:26112
ds_read_b64_tr_b16 v[180:181], v2 offset:24640
ds_read_b64_tr_b16 v[182:183], v2 offset:26176
ds_read_b64_tr_b16 v[184:185], v2 offset:24704
ds_read_b64_tr_b16 v[186:187], v2 offset:26240
buffer_load_dwordx4 v[108:111], v4, s[8:11], s29 offen offset:3072 sc1
s_add_u32 s29, s29, 4096
s_waitcnt vmcnt(4) lgkmcnt(6)
v_mfma_f32_32x32x16_bf16 v[128:143], v[188:191], v[92:95], v[128:143]
v_mfma_f32_32x32x16_bf16 v[144:159], v[192:195], v[92:95], v[144:159]
v_mfma_f32_32x32x16_bf16 v[160:175], v[196:199], v[92:95], v[160:175]
ds_read_b64_tr_b16 v[188:189], v2 offset:27648
ds_read_b64_tr_b16 v[190:191], v2 offset:29184
ds_read_b64_tr_b16 v[192:193], v2 offset:27712
ds_read_b64_tr_b16 v[194:195], v2 offset:29248
ds_read_b64_tr_b16 v[196:197], v2 offset:27776
ds_read_b64_tr_b16 v[198:199], v2 offset:29312
buffer_load_dwordx4 v[112:115], v4, s[8:11], s29 offen offset:0 sc1
s_waitcnt vmcnt(4) lgkmcnt(6)
v_mfma_f32_32x32x16_bf16 v[128:143], v[176:179], v[96:99], v[128:143]
v_mfma_f32_32x32x16_bf16 v[144:159], v[180:183], v[96:99], v[144:159]
v_mfma_f32_32x32x16_bf16 v[160:175], v[184:187], v[96:99], v[160:175]
ds_read_b64_tr_b16 v[176:177], v2 offset:30720
ds_read_b64_tr_b16 v[178:179], v2 offset:32256
ds_read_b64_tr_b16 v[180:181], v2 offset:30784
ds_read_b64_tr_b16 v[182:183], v2 offset:32320
ds_read_b64_tr_b16 v[184:185], v2 offset:30848
ds_read_b64_tr_b16 v[186:187], v2 offset:32384
buffer_load_dwordx4 v[116:119], v4, s[8:11], s29 offen offset:1024 sc1
s_waitcnt vmcnt(4) lgkmcnt(6)
v_mfma_f32_32x32x16_bf16 v[128:143], v[188:191], v[100:103], v[128:143]
v_mfma_f32_32x32x16_bf16 v[144:159], v[192:195], v[100:103], v[144:159]
v_mfma_f32_32x32x16_bf16 v[160:175], v[196:199], v[100:103], v[160:175]
ds_read_b64_tr_b16 v[188:189], v2 offset:33792
ds_read_b64_tr_b16 v[190:191], v2 offset:35328
ds_read_b64_tr_b16 v[192:193], v2 offset:33856
ds_read_b64_tr_b16 v[194:195], v2 offset:35392
ds_read_b64_tr_b16 v[196:197], v2 offset:33920
ds_read_b64_tr_b16 v[198:199], v2 offset:35456
buffer_load_dwordx4 v[120:123], v4, s[8:11], s29 offen offset:2048 sc1
s_waitcnt vmcnt(4) lgkmcnt(6)
v_mfma_f32_32x32x16_bf16 v[128:143], v[176:179], v[104:107], v[128:143]
v_mfma_f32_32x32x16_bf16 v[144:159], v[180:183], v[104:107], v[144:159]
v_mfma_f32_32x32x16_bf16 v[160:175], v[184:187], v[104:107], v[160:175]
ds_read_b64_tr_b16 v[176:177], v2 offset:36864
ds_read_b64_tr_b16 v[178:179], v2 offset:38400
ds_read_b64_tr_b16 v[180:181], v2 offset:36928
ds_read_b64_tr_b16 v[182:183], v2 offset:38464
ds_read_b64_tr_b16 v[184:185], v2 offset:36992
ds_read_b64_tr_b16 v[186:187], v2 offset:38528
buffer_load_dwordx4 v[124:127], v4, s[8:11], s29 offen offset:3072 sc1
s_add_u32 s29, s29, 4096
s_waitcnt vmcnt(4) lgkmcnt(6)
v_mfma_f32_32x32x16_bf16 v[128:143], v[188:191], v[108:111], v[128:143]
v_mfma_f32_32x32x16_bf16 v[144:159], v[192:195], v[108:111], v[144:159]
v_mfma_f32_32x32x16_bf16 v[160:175], v[196:199], v[108:111], v[160:175]
ds_read_b64_tr_b16 v[188:189], v2 offset:39936
ds_read_b64_tr_b16 v[190:191], v2 offset:41472
ds_read_b64_tr_b16 v[192:193], v2 offset:40000
ds_read_b64_tr_b16 v[194:195], v2 offset:41536
ds_read_b64_tr_b16 v[196:197], v2 offset:40064
ds_read_b64_tr_b16 v[198:199], v2 offset:41600
s_waitcnt vmcnt(3) lgkmcnt(6)
v_mfma_f32_32x32x16_bf16 v[128:143], v[176:179], v[112:115], v[128:143]
v_mfma_f32_32x32x16_bf16 v[144:159], v[180:183], v[112:115], v[144:159]
v_mfma_f32_32x32x16_bf16 v[160:175], v[184:187], v[112:115], v[160:175]
ds_read_b64_tr_b16 v[176:177], v2 offset:43008
ds_read_b64_tr_b16 v[178:179], v2 offset:44544
ds_read_b64_tr_b16 v[180:181], v2 offset:43072
ds_read_b64_tr_b16 v[182:183], v2 offset:44608
ds_read_b64_tr_b16 v[184:185], v2 offset:43136
ds_read_b64_tr_b16 v[186:187], v2 offset:44672
s_waitcnt vmcnt(2) lgkmcnt(6)
v_mfma_f32_32x32x16_bf16 v[128:143], v[188:191], v[116:119], v[128:143]
v_mfma_f32_32x32x16_bf16 v[144:159], v[192:195], v[116:119], v[144:159]
v_mfma_f32_32x32x16_bf16 v[160:175], v[196:199], v[116:119], v[160:175]
ds_read_b64_tr_b16 v[188:189], v2 offset:46080
ds_read_b64_tr_b16 v[190:191], v2 offset:47616
ds_read_b64_tr_b16 v[192:193], v2 offset:46144
ds_read_b64_tr_b16 v[194:195], v2 offset:47680
ds_read_b64_tr_b16 v[196:197], v2 offset:46208
ds_read_b64_tr_b16 v[198:199], v2 offset:47744
s_waitcnt vmcnt(1) lgkmcnt(6)
v_mfma_f32_32x32x16_bf16 v[128:143], v[176:179], v[120:123], v[128:143]
v_mfma_f32_32x32x16_bf16 v[144:159], v[180:183], v[120:123], v[144:159]
v_mfma_f32_32x32x16_bf16 v[160:175], v[184:187], v[120:123], v[160:175]
s_waitcnt vmcnt(0) lgkmcnt(0)
v_mfma_f32_32x32x16_bf16 v[128:143], v[188:191], v[124:127], v[128:143]
v_mfma_f32_32x32x16_bf16 v[144:159], v[192:195], v[124:127], v[144:159]
v_mfma_f32_32x32x16_bf16 v[160:175], v[196:199], v[124:127], v[160:175]
s_nop 7
s_barrier
s_mul_i32 s38, s5, 6144
s_add_u32 s38, s38, 65536
v_add_u32 v5, s38, v4
s_nop 7
s_cmp_eq_u32 s27, 1
s_cbranch_scc1 L_k1_61
ds_write_b128 v5, v[144:147] offset:0
ds_write_b128 v5, v[148:151] offset:1024
ds_write_b128 v5, v[152:155] offset:2048
ds_write_b128 v5, v[156:159] offset:3072
ds_write_b128 v5, v[168:171] offset:4096
ds_write_b128 v5, v[172:175] offset:5120
s_branch L_j_62
L_k1_61:
ds_write_b128 v5, v[128:131] offset:0
ds_write_b128 v5, v[132:135] offset:1024
ds_write_b128 v5, v[136:139] offset:2048
ds_write_b128 v5, v[140:143] offset:3072
ds_write_b128 v5, v[160:163] offset:4096
ds_write_b128 v5, v[164:167] offset:5120
L_j_62:
s_waitcnt lgkmcnt(0)
s_barrier
s_xor_b32 s38, s5, 4
s_mul_i32 s38, s38, 6144
s_add_u32 s38, s38, 65536
v_add_u32 v5, s38, v4
ds_read_b128 v[200:203], v5 offset:0
ds_read_b128 v[204:207], v5 offset:1024
ds_read_b128 v[208:211], v5 offset:2048
ds_read_b128 v[212:215], v5 offset:3072
ds_read_b128 v[216:219], v5 offset:4096
ds_read_b128 v[220:223], v5 offset:5120
s_waitcnt vmcnt(0)
v_add_f32 v24, v24, v26
v_add_f32 v25, v25, v27
v_add_f32 v28, v28, v30
v_add_f32 v29, v29, v31
v_add_f32 v224, v24, v28
v_add_f32 v225, v25, v29
v_mov_b32 v226, v224
v_mov_b32 v227, v225
s_nop 1
v_permlane32_swap_b32 v224, v226
v_permlane32_swap_b32 v225, v227
s_nop 1
v_add_f32 v224, v224, v226
v_add_f32 v225, v225, v227
v_mul_f32 v224, 0x3b000000, v224
v_mul_f32 v225, 0x3b000000, v225
v_fma_f32 v225, -v224, v224, v225
v_max_f32 v225, 0, v225
v_add_f32 v225, 0x3727c5ac, v225
v_rsq_f32 v230, v225
v_lshlrev_b32 v104, 16, v36
v_and_b32 v105, 0xffff0000, v36
v_lshlrev_b32 v106, 16, v37
v_and_b32 v107, 0xffff0000, v37
v_lshlrev_b32 v108, 16, v38
v_and_b32 v109, 0xffff0000, v38
v_lshlrev_b32 v110, 16, v39
v_and_b32 v111, 0xffff0000, v39
v_lshlrev_b32 v112, 16, v40
v_and_b32 v113, 0xffff0000, v40
v_lshlrev_b32 v114, 16, v41
v_and_b32 v115, 0xffff0000, v41
v_lshlrev_b32 v116, 16, v42
v_and_b32 v117, 0xffff0000, v42
v_lshlrev_b32 v118, 16, v43
v_and_b32 v119, 0xffff0000, v43
v_lshlrev_b32 v120, 16, v44
v_and_b32 v121, 0xffff0000, v44
v_lshlrev_b32 v122, 16, v45
v_and_b32 v123, 0xffff0000, v45
v_lshlrev_b32 v124, 16, v46
v_and_b32 v125, 0xffff0000, v46
v_lshlrev_b32 v126, 16, v47
v_and_b32 v127, 0xffff0000, v47
v_mov_b32 v231, v230
v_mul_f32 v228, v224, v230
v_mov_b32 v229, v228
s_mov_b32 s42, 0xbdd2d3e8
s_mov_b32 s43, 0xbdd2d3e8
v_mov_b32 v16, 0xc0135761
v_mov_b32 v17, 0xc0135761
v_mov_b32 v18, 1.0
v_mov_b32 v19, 1.0
v_pk_fma_f32 v[104:105], v[228:229], v[232:233], v[104:105] neg_lo:[1,0,0] neg_hi:[1,0,0]
v_pk_fma_f32 v[106:107], v[228:229], v[234:235], v[106:107] neg_lo:[1,0,0] neg_hi:[1,0,0]
v_pk_fma_f32 v[108:109], v[228:229], v[236:237], v[108:109] neg_lo:[1,0,0] neg_hi:[1,0,0]
v_pk_fma_f32 v[110:111], v[228:229], v[238:239], v[110:111] neg_lo:[1,0,0] neg_hi:[1,0,0]
v_pk_fma_f32 v[112:113], v[228:229], v[240:241], v[112:113] neg_lo:[1,0,0] neg_hi:[1,0,0]
v_pk_fma_f32 v[114:115], v[228:229], v[242:243], v[114:115] neg_lo:[1,0,0] neg_hi:[1,0,0]
v_pk_fma_f32 v[116:117], v[228:229], v[244:245], v[116:117] neg_lo:[1,0,0] neg_hi:[1,0,0]
v_pk_fma_f32 v[118:119], v[228:229], v[246:247], v[118:119] neg_lo:[1,0,0] neg_hi:[1,0,0]
v_pk_fma_f32 v[120:121], v[228:229], v[48:49], v[120:121] neg_lo:[1,0,0] neg_hi:[1,0,0]
v_pk_fma_f32 v[122:123], v[228:229], v[50:51], v[122:123] neg_lo:[1,0,0] neg_hi:[1,0,0]
v_pk_fma_f32 v[124:125], v[228:229], v[52:53], v[124:125] neg_lo:[1,0,0] neg_hi:[1,0,0]
v_pk_fma_f32 v[126:127], v[228:229], v[54:55], v[126:127] neg_lo:[1,0,0] neg_hi:[1,0,0]
s_waitcnt lgkmcnt(0)
s_cmp_eq_u32 s27, 1
s_cbranch_scc1 L_k1_63
v_pk_add_f32 v[200:201], v[200:201], v[128:129]
v_pk_add_f32 v[202:203], v[202:203], v[130:131]
v_pk_add_f32 v[204:205], v[204:205], v[132:133]
v_pk_add_f32 v[206:207], v[206:207], v[134:135]
v_pk_add_f32 v[208:209], v[208:209], v[136:137]
v_pk_add_f32 v[210:211], v[210:211], v[138:139]
v_pk_add_f32 v[212:213], v[212:213], v[140:141]
v_pk_add_f32 v[214:215], v[214:215], v[142:143]
v_pk_add_f32 v[216:217], v[216:217], v[160:161]
v_pk_add_f32 v[218:219], v[218:219], v[162:163]
v_pk_add_f32 v[220:221], v[220:221], v[164:165]
v_pk_add_f32 v[222:223], v[222:223], v[166:167]
s_branch L_j_64
L_k1_63:
v_pk_add_f32 v[200:201], v[200:201], v[144:145]
v_pk_add_f32 v[202:203], v[202:203], v[146:147]
v_pk_add_f32 v[204:205], v[204:205], v[148:149]
v_pk_add_f32 v[206:207], v[206:207], v[150:151]
v_pk_add_f32 v[208:209], v[208:209], v[152:153]
v_pk_add_f32 v[210:211], v[210:211], v[154:155]
v_pk_add_f32 v[212:213], v[212:213], v[156:157]
v_pk_add_f32 v[214:215], v[214:215], v[158:159]
v_pk_add_f32 v[216:217], v[216:217], v[168:169]
v_pk_add_f32 v[218:219], v[218:219], v[170:171]
v_pk_add_f32 v[220:221], v[220:221], v[172:173]
v_pk_add_f32 v[222:223], v[222:223], v[174:175]
L_j_64:
v_pk_fma_f32 v[200:201], v[200:201], v[230:231], v[104:105]
v_pk_fma_f32 v[202:203], v[202:203], v[230:231], v[106:107]
v_pk_fma_f32 v[204:205], v[204:205], v[230:231], v[108:109]
v_pk_fma_f32 v[206:207], v[206:207], v[230:231], v[110:111]
v_pk_mul_f32 v[176:177], v[200:201], v[200:201]
v_pk_mul_f32 v[178:179], v[202:203], v[202:203]
v_pk_mul_f32 v[180:181], v[204:205], v[204:205]
v_pk_mul_f32 v[182:183], v[206:207], v[206:207]
v_pk_fma_f32 v[176:177], v[176:177], s[42:43], v[16:17]
v_pk_fma_f32 v[178:179], v[178:179], s[42:43], v[16:17]
v_pk_fma_f32 v[180:181], v[180:181], s[42:43], v[16:17]
v_pk_fma_f32 v[182:183], v[182:183], s[42:43], v[16:17]
v_pk_mul_f32 v[176:177], v[176:177], v[200:201]
v_pk_mul_f32 v[178:179], v[178:179], v[202:203]
v_pk_mul_f32 v[180:181], v[180:181], v[204:205]
v_pk_mul_f32 v[182:183], v[182:183], v[206:207]
v_exp_f32 v176, v176
v_exp_f32 v177, v177
v_exp_f32 v178, v178
v_exp_f32 v179, v179
v_exp_f32 v180, v180
v_exp_f32 v181, v181
v_exp_f32 v182, v182
v_exp_f32 v183, v183
s_add_u32 m0, s45, 0
s_add_u32 s47, s44, 327680
buffer_load_dwordx4 v21, s[12:15], s47 offen lds
s_add_u32 m0, s45, 8192
s_add_u32 s47, s44, 344064
buffer_load_dwordx4 v21, s[12:15], s47 offen lds
s_add_u32 m0, s45, 16384
s_add_u32 s47, s44, 32768
buffer_load_dwordx4 v21, s[12:15], s47 offen lds
v_pk_add_f32 v[176:177], v[176:177], v[18:19]
v_pk_add_f32 v[178:179], v[178:179], v[18:19]
v_pk_add_f32 v[180:181], v[180:181], v[18:19]
v_pk_add_f32 v[182:183], v[182:183], v[18:19]
v_rcp_f32 v176, v176
v_rcp_f32 v177, v177
v_rcp_f32 v178, v178
v_rcp_f32 v179, v179
v_rcp_f32 v180, v180
v_rcp_f32 v181, v181
v_rcp_f32 v182, v182
v_rcp_f32 v183, v183
s_nop 0
v_pk_mul_f32 v[200:201], v[200:201], v[176:177]
v_pk_mul_f32 v[202:203], v[202:203], v[178:179]
v_pk_mul_f32 v[204:205], v[204:205], v[180:181]
v_pk_mul_f32 v[206:207], v[206:207], v[182:183]
v_pk_fma_f32 v[208:209], v[208:209], v[230:231], v[112:113]
v_pk_fma_f32 v[210:211], v[210:211], v[230:231], v[114:115]
v_pk_fma_f32 v[212:213], v[212:213], v[230:231], v[116:117]
v_pk_fma_f32 v[214:215], v[214:215], v[230:231], v[118:119]
v_pk_mul_f32 v[176:177], v[208:209], v[208:209]
v_pk_mul_f32 v[178:179], v[210:211], v[210:211]
v_pk_mul_f32 v[180:181], v[212:213], v[212:213]
v_pk_mul_f32 v[182:183], v[214:215], v[214:215]
v_pk_fma_f32 v[176:177], v[176:177], s[42:43], v[16:17]
v_pk_fma_f32 v[178:179], v[178:179], s[42:43], v[16:17]
v_pk_fma_f32 v[180:181], v[180:181], s[42:43], v[16:17]
v_pk_fma_f32 v[182:183], v[182:183], s[42:43], v[16:17]
v_pk_mul_f32 v[176:177], v[176:177], v[208:209]
v_pk_mul_f32 v[178:179], v[178:179], v[210:211]
v_pk_mul_f32 v[180:181], v[180:181], v[212:213]
v_pk_mul_f32 v[182:183], v[182:183], v[214:215]
v_exp_f32 v176, v176
v_exp_f32 v177, v177
v_exp_f32 v178, v178
v_exp_f32 v179, v179
v_exp_f32 v180, v180
v_exp_f32 v181, v181
v_exp_f32 v182, v182
v_exp_f32 v183, v183
s_add_u32 m0, s45, 24576
s_add_u32 s47, s44, 49152
buffer_load_dwordx4 v21, s[12:15], s47 offen lds
s_add_u32 m0, s45, 32768
s_add_u32 s47, s44, 65536
buffer_load_dwordx4 v21, s[12:15], s47 offen lds
s_add_u32 m0, s45, 40960
s_add_u32 s47, s44, 81920
buffer_load_dwordx4 v21, s[12:15], s47 offen lds
v_pk_add_f32 v[176:177], v[176:177], v[18:19]
v_pk_add_f32 v[178:179], v[178:179], v[18:19]
v_pk_add_f32 v[180:181], v[180:181], v[18:19]
v_pk_add_f32 v[182:183], v[182:183], v[18:19]
v_rcp_f32 v176, v176
v_rcp_f32 v177, v177
v_rcp_f32 v178, v178
v_rcp_f32 v179, v179
v_rcp_f32 v180, v180
v_rcp_f32 v181, v181
v_rcp_f32 v182, v182
v_rcp_f32 v183, v183
s_nop 0
v_pk_mul_f32 v[208:209], v[208:209], v[176:177]
v_pk_mul_f32 v[210:211], v[210:211], v[178:179]
v_pk_mul_f32 v[212:213], v[212:213], v[180:181]
v_pk_mul_f32 v[214:215], v[214:215], v[182:183]
v_pk_fma_f32 v[216:217], v[216:217], v[230:231], v[120:121]
v_pk_fma_f32 v[218:219], v[218:219], v[230:231], v[122:123]
v_pk_fma_f32 v[220:221], v[220:221], v[230:231], v[124:125]
v_pk_fma_f32 v[222:223], v[222:223], v[230:231], v[126:127]
v_pk_mul_f32 v[176:177], v[216:217], v[216:217]
v_pk_mul_f32 v[178:179], v[218:219], v[218:219]
v_pk_mul_f32 v[180:181], v[220:221], v[220:221]
v_pk_mul_f32 v[182:183], v[222:223], v[222:223]
v_pk_fma_f32 v[176:177], v[176:177], s[42:43], v[16:17]
v_pk_fma_f32 v[178:179], v[178:179], s[42:43], v[16:17]
v_pk_fma_f32 v[180:181], v[180:181], s[42:43], v[16:17]
v_pk_fma_f32 v[182:183], v[182:183], s[42:43], v[16:17]
v_pk_mul_f32 v[176:177], v[176:177], v[216:217]
v_pk_mul_f32 v[178:179], v[178:179], v[218:219]
v_pk_mul_f32 v[180:181], v[180:181], v[220:221]
v_pk_mul_f32 v[182:183], v[182:183], v[222:223]
v_exp_f32 v176, v176
v_exp_f32 v177, v177
v_exp_f32 v178, v178
v_exp_f32 v179, v179
v_exp_f32 v180, v180
v_exp_f32 v181, v181
v_exp_f32 v182, v182
v_exp_f32 v183, v183
s_add_u32 m0, s45, 49152
s_add_u32 s47, s44, 98304
buffer_load_dwordx4 v21, s[12:15], s47 offen lds
s_add_u32 m0, s45, 57344
s_add_u32 s47, s44, 114688
buffer_load_dwordx4 v21, s[12:15], s47 offen lds
v_pk_add_f32 v[176:177], v[176:177], v[18:19]
v_pk_add_f32 v[178:179], v[178:179], v[18:19]
v_pk_add_f32 v[180:181], v[180:181], v[18:19]
v_pk_add_f32 v[182:183], v[182:183], v[18:19]
v_rcp_f32 v176, v176
v_rcp_f32 v177, v177
v_rcp_f32 v178, v178
v_rcp_f32 v179, v179
v_rcp_f32 v180, v180
v_rcp_f32 v181, v181
v_rcp_f32 v182, v182
v_rcp_f32 v183, v183
s_nop 0
v_pk_mul_f32 v[216:217], v[216:217], v[176:177]
v_pk_mul_f32 v[218:219], v[218:219], v[178:179]
v_pk_mul_f32 v[220:221], v[220:221], v[180:181]
v_pk_mul_f32 v[222:223], v[222:223], v[182:183]
v_cvt_pk_bf16_f32 v128, v200, v201
v_cvt_pk_bf16_f32 v129, v202, v203
v_cvt_pk_bf16_f32 v130, v204, v205
v_cvt_pk_bf16_f32 v131, v206, v207
v_cvt_pk_bf16_f32 v132, v208, v209
v_cvt_pk_bf16_f32 v133, v210, v211
v_cvt_pk_bf16_f32 v134, v212, v213
v_cvt_pk_bf16_f32 v135, v214, v215
v_cvt_pk_bf16_f32 v136, v216, v217
v_cvt_pk_bf16_f32 v137, v218, v219
v_cvt_pk_bf16_f32 v138, v220, v221
v_cvt_pk_bf16_f32 v139, v222, v223
s_mul_i32 s40, s28, 86
s_mul_i32 s41, s25, 6
s_add_u32 s40, s40, s41
s_lshl_b32 s41, s27, 1
s_add_u32 s41, s41, s40
s_lshl_b32 s41, s41, 10
s_add_u32 s41, s41, 10485760
s_cmp_eq_u32 s25, 14
s_cselect_b32 s42, 1, 0
s_and_b32 s43, s42, s27
s_cmp_eq_u32 s43, 1
s_cbranch_scc1 L_skip2_66
buffer_store_dwordx4 v[128:131], v4, s[8:11], s41 offen sc1
buffer_store_dwordx4 v[132:135], v4, s[8:11], s41 offen offset:1024 sc1
L_skip2_66:
s_mov_b32 s52, s41
s_mov_b32 s53, s41
s_cmp_eq_u32 s42, 1
s_cbranch_scc1 L_skip_65
s_add_u32 s41, s40, s27
s_add_u32 s41, s41, 4
s_lshl_b32 s41, s41, 10
s_add_u32 s41, s41, 10485760
buffer_store_dwordx4 v[136:139], v4, s[8:11], s41 offen sc1
s_mov_b32 s53, s41
L_skip_65:
s_waitcnt vmcnt(0)
s_branch L_p4end_54
L_p4idle_55:
s_cmp_lg_u32 s3, 1
s_cbranch_scc1 L_nep_67
s_cmp_lg_u32 s5, 0
s_cbranch_scc1 L_nep_67
v_lshlrev_b32 v253, 2, v1
s_mov_b32 s61, 400015
s_mov_b32 s62, 16777216
L_epl_68:
buffer_load_dword v64, v253, s[8:11], s62 offen offset:0 sc1
buffer_load_dword v65, v253, s[8:11], s62 offen offset:256 sc1
buffer_load_dword v66, v253, s[8:11], s62 offen offset:512 sc1
buffer_load_dword v67, v253, s[8:11], s62 offen offset:768 sc1
s_waitcnt vmcnt(0)
v_xor_b32 v64, s60, v64
v_xor_b32 v65, s60, v65
v_xor_b32 v66, s60, v66
v_xor_b32 v67, s60, v67
v_or_b32 v64, v64, v65
v_or_b32 v66, v66, v67
v_or_b32 v64, v64, v66
v_cmp_ne_u32 vcc, 0, v64
s_cbranch_vccz L_epd_69
s_sub_u32 s61, s61, 1
s_cbranch_scc0 L_epl_68
L_epd_69:
s_mov_b32 s62, 16793600
s_mov_b64 exec, 1
v_mov_b32 v254, s60
buffer_store_dword v254, off, s[8:11], s62 sc1
s_mov_b64 exec, -1
L_nep_67:
s_add_u32 m0, s45, 0
s_add_u32 s47, s44, 327680
buffer_load_dwordx4 v21, s[12:15], s47 offen lds
s_add_u32 m0, s45, 8192
s_add_u32 s47, s44, 344064
buffer_load_dwordx4 v21, s[12:15], s47 offen lds
s_add_u32 m0, s45, 16384
s_add_u32 s47, s44, 32768
buffer_load_dwordx4 v21, s[12:15], s47 offen lds
s_add_u32 m0, s45, 24576
s_add_u32 s47, s44, 49152
buffer_load_dwordx4 v21, s[12:15], s47 offen lds
s_add_u32 m0, s45, 32768
s_add_u32 s47, s44, 65536
buffer_load_dwordx4 v21, s[12:15], s47 offen lds
s_add_u32 m0, s45, 40960
s_add_u32 s47, s44, 81920
buffer_load_dwordx4 v21, s[12:15], s47 offen lds
s_add_u32 m0, s45, 49152
s_add_u32 s47, s44, 98304
buffer_load_dwordx4 v21, s[12:15], s47 offen lds
s_add_u32 m0, s45, 57344
s_add_u32 s47, s44, 114688
buffer_load_dwordx4 v21, s[12:15], s47 offen lds
s_waitcnt vmcnt(0)
L_p4end_54:
s_barrier
s_cmp_lg_u32 s5, 0
s_cbranch_scc1 L_nf_70
s_lshl_b32 s62, s24, 7
s_lshl_b32 s6, s25, 2
s_add_u32 s62, s62, s6
s_add_u32 s62, s62, 16789504
s_mov_b64 exec, 1
v_mov_b32 v254, s60
buffer_store_dword v254, off, s[8:11], s62 sc1
s_mov_b64 exec, -1
L_nf_70:
s_and_b32 s26, s5, 1
s_lshr_b32 s27, s5, 1
s_lshl_b32 s28, s3, 1
s_add_u32 s28, s28, s26
s_mov_b32 s16, s78
s_mov_b32 s17, s79
s_mov_b32 s18, 1024
s_mov_b32 s19, 0x20000
s_mov_b32 s20, s80
s_mov_b32 s21, s81
s_mov_b32 s22, 2097152
s_mov_b32 s23, 0x20000
s_mul_i32 s29, s27, 22
s_cmp_eq_u32 s27, 3
s_cselect_b32 s30, 1, 0
s_sub_u32 s29, s29, s30
s_mov_b32 s12, s76
s_mov_b32 s13, s77
s_mov_b32 s14, 1409024
s_mov_b32 s15, 0x20000
v_lshrrev_b32 v20, 3, v1
v_mul_u32_u24 v20, 1024, v20
v_bfe_u32 v8, v1, 4, 1
v_lshlrev_b32 v8, 2, v8
v_xor_b32 v8, v8, v1
v_and_b32 v8, 7, v8
v_lshlrev_b32 v8, 4, v8
v_add_u32 v20, v20, v8
s_lshr_b32 s46, s5, 1
s_mul_i32 s44, s46, 22
s_cmp_eq_u32 s46, 3
s_cselect_b32 s47, 1, 0
s_sub_u32 s44, s44, s47
s_lshl_b32 s44, s44, 14
s_and_b32 s47, s5, 1
s_lshl_b32 s45, s47, 13
s_add_u32 s44, s44, s45
s_lshl_b32 s45, s4, 7
s_add_u32 s44, s44, s45
s_lshl_b32 s45, s46, 11
s_lshl_b32 s47, s47, 10
s_add_u32 s45, s45, s47
v_lshlrev_b32 v8, 4, v1
s_mul_i32 s34, s28, 86
s_add_u32 s34, s34, s29
s_lshl_b32 s34, s34, 10
s_add_u32 s34, s34, 10485760
v_lshrrev_b32 v15, 5, v1
v_and_b32 v16, 31, v1
v_lshlrev_b32 v18, 3, v15
s_lshl_b32 s35, s4, 7
s_lshl_b32 s36, s27, 5
s_add_u32 s35, s35, s36
buffer_load_dwordx2 v[236:237], v18, s[16:19], s35 offen
buffer_load_dwordx2 v[238:239], v18, s[16:19], s35 offen offset:16
v_lshlrev_b32 v12, 9, v15
v_bfe_u32 v13, v1, 2, 2
v_lshlrev_b32 v13, 7, v13
v_add_u32 v12, v12, v13
v_bfe_u32 v13, v1, 3, 1
v_lshlrev_b32 v13, 6, v13
v_add_u32 v12, v12, v13
v_bfe_u32 v13, v1, 4, 1
v_lshlrev_b32 v13, 5, v13
v_add_u32 v12, v12, v13
v_and_b32 v13, 3, v1
v_lshlrev_b32 v13, 3, v13
v_add_u32 v12, v12, v13
s_lshl_b32 s36, s27, 11
v_add_u32 v2, s36, v12
v_xor_b32 v3, 64, v2
v_add_u32 v4, 65536, v2
v_add_u32 v5, 65536, v3
v_add_u32 v6, 131072, v2
v_add_u32 v7, 131072, v3
v_mov_b32 v160, 0
v_mov_b32 v161, 0
v_mov_b32 v162, 0
v_mov_b32 v163, 0
v_mov_b32 v164, 0
v_mov_b32 v165, 0
v_mov_b32 v166, 0
v_mov_b32 v167, 0
v_mov_b32 v168, 0
v_mov_b32 v169, 0
v_mov_b32 v170, 0
v_mov_b32 v171, 0
v_mov_b32 v172, 0
v_mov_b32 v173, 0
v_mov_b32 v174, 0
v_mov_b32 v175, 0
v_mov_b32 v176, 0
v_mov_b32 v177, 0
v_mov_b32 v178, 0
v_mov_b32 v179, 0
v_mov_b32 v180, 0
v_mov_b32 v181, 0
v_mov_b32 v182, 0
v_mov_b32 v183, 0
v_mov_b32 v184, 0
v_mov_b32 v185, 0
v_mov_b32 v186, 0
v_mov_b32 v187, 0
v_mov_b32 v188, 0
v_mov_b32 v189, 0
v_mov_b32 v190, 0
v_mov_b32 v191, 0
ds_read_b64_tr_b16 v[24:25], v2 offset:0
ds_read_b64_tr_b16 v[26:27], v2 offset:1024
ds_read_b64_tr_b16 v[28:29], v3 offset:0
ds_read_b64_tr_b16 v[30:31], v3 offset:1024
ds_read_b64_tr_b16 v[32:33], v2 offset:8192
ds_read_b64_tr_b16 v[34:35], v2 offset:9216
ds_read_b64_tr_b16 v[36:37], v3 offset:8192
ds_read_b64_tr_b16 v[38:39], v3 offset:9216
s_waitcnt lgkmcnt(0)
s_barrier
s_add_u32 m0, s45, 0
s_add_u32 s47, s44, 0
buffer_load_dwordx4 v20, s[12:15], s47 offen lds
s_add_u32 m0, s45, 8192
s_add_u32 s47, s44, 16384
buffer_load_dwordx4 v20, s[12:15], s47 offen lds
s_add_u32 m0, s45, 65536
s_add_u32 s47, s44, 131072
buffer_load_dwordx4 v20, s[12:15], s47 offen lds
s_add_u32 m0, s45, 73728
s_add_u32 s47, s44, 147456
buffer_load_dwordx4 v20, s[12:15], s47 offen lds
s_add_u32 m0, s45, 81920
s_add_u32 s47, s44, 163840
buffer_load_dwordx4 v20, s[12:15], s47 offen lds
s_add_u32 m0, s45, 90112
s_add_u32 s47, s44, 180224
buffer_load_dwordx4 v20, s[12:15], s47 offen lds
s_add_u32 m0, s45, 98304
s_add_u32 s47, s44, 196608
buffer_load_dwordx4 v20, s[12:15], s47 offen lds
s_add_u32 m0, s45, 106496
s_add_u32 s47, s44, 212992
buffer_load_dwordx4 v20, s[12:15], s47 offen lds
s_add_u32 m0, s45, 114688
s_add_u32 s47, s44, 229376
buffer_load_dwordx4 v20, s[12:15], s47 offen lds
s_add_u32 m0, s45, 122880
s_add_u32 s47, s44, 245760
buffer_load_dwordx4 v20, s[12:15], s47 offen lds
s_add_u32 m0, s45, 131072
s_add_u32 s47, s44, 262144
buffer_load_dwordx4 v20, s[12:15], s47 offen lds
s_add_u32 m0, s45, 139264
s_add_u32 s47, s44, 278528
buffer_load_dwordx4 v20, s[12:15], s47 offen lds
s_add_u32 m0, s45, 147456
s_add_u32 s47, s44, 294912
buffer_load_dwordx4 v20, s[12:15], s47 offen lds
s_add_u32 m0, s45, 155648
s_add_u32 s47, s44, 311296
buffer_load_dwordx4 v20, s[12:15], s47 offen lds
s_cmp_lg_u32 s5, 0
s_cbranch_scc1 L_po_71
v_lshlrev_b32 v253, 2, v1
s_lshr_b32 s62, s3, 1
s_lshl_b32 s62, s62, 7
s_add_u32 s62, s62, 16789504
s_mov_b64 s[6:7], 0xffff
s_cmp_eq_u64 s[6:7], 0
s_cbranch_scc1 L_pd_74
s_mov_b64 exec, s[6:7]
s_mov_b32 s61, 400015
s_add_u32 s56, s84, s62
s_addc_u32 s57, s85, 0
L_pl_73:
s_load_dwordx8 s[88:95], s[56:57], 0 glc
s_load_dwordx8 s[48:55], s[56:57], 32 glc
s_waitcnt lgkmcnt(0)
s_xor_b64 s[88:89], s[88:89], s[100:101]
s_xor_b64 s[90:91], s[90:91], s[100:101]
s_xor_b64 s[92:93], s[92:93], s[100:101]
s_xor_b64 s[94:95], s[94:95], s[100:101]
s_xor_b64 s[48:49], s[48:49], s[100:101]
s_xor_b64 s[50:51], s[50:51], s[100:101]
s_xor_b64 s[52:53], s[52:53], s[100:101]
s_xor_b64 s[54:55], s[54:55], s[100:101]
s_or_b64 s[88:89], s[88:89], s[48:49]
s_or_b64 s[90:91], s[90:91], s[50:51]
s_or_b64 s[92:93], s[92:93], s[52:53]
s_or_b64 s[94:95], s[94:95], s[54:55]
s_or_b64 s[88:89], s[88:89], s[90:91]
s_or_b64 s[92:93], s[92:93], s[94:95]
s_or_b64 s[52:53], s[88:89], s[92:93]
s_cmp_eq_u64 s[52:53], 0
s_cbranch_scc1 L_pd_74
s_and_b32 s58, s61, 15
s_cbranch_scc1 L_pv_75
buffer_load_dword v254, v253, s[8:11], s62 offen sc1
s_waitcnt vmcnt(0)
v_cmp_ne_u32 vcc, s60, v254
s_cbranch_vccz L_pd_74
L_pv_75:
s_sub_u32 s61, s61, 1
s_cbranch_scc0 L_pl_73
L_pd_74:
s_mov_b64 exec, -1
L_po_71:
s_barrier
buffer_load_dwordx4 v[64:67], v8, s[8:11], s34 offen offset:0 sc1
buffer_load_dwordx4 v[68:71], v8, s[8:11], s34 offen offset:1024 sc1
buffer_load_dwordx4 v[72:75], v8, s[8:11], s34 offen offset:2048 sc1
buffer_load_dwordx4 v[76:79], v8, s[8:11], s34 offen offset:3072 sc1
s_add_u32 s34, s34, 4096
buffer_load_dwordx4 v[80:83], v8, s[8:11], s34 offen offset:0 sc1
s_waitcnt vmcnt(5)
s_barrier
ds_read_b64_tr_b16 v[192:193], v2 offset:0
ds_read_b64_tr_b16 v[194:195], v2 offset:1024
ds_read_b64_tr_b16 v[196:197], v3 offset:0
ds_read_b64_tr_b16 v[198:199], v3 offset:1024
ds_read_b64_tr_b16 v[200:201], v2 offset:8192
ds_read_b64_tr_b16 v[202:203], v2 offset:9216
ds_read_b64_tr_b16 v[204:205], v3 offset:8192
ds_read_b64_tr_b16 v[206:207], v3 offset:9216
buffer_load_dwordx4 v[84:87], v8, s[8:11], s34 offen offset:1024 sc1
s_waitcnt vmcnt(5) lgkmcnt(4)
v_mfma_f32_32x32x16_bf16 v[160:175], v[192:195], v[64:67], v[160:175]
v_mfma_f32_32x32x16_bf16 v[176:191], v[196:199], v[64:67], v[176:191]
ds_read_b64_tr_b16 v[192:193], v2 offset:16384
ds_read_b64_tr_b16 v[194:195], v2 offset:17408
ds_read_b64_tr_b16 v[196:197], v3 offset:16384
ds_read_b64_tr_b16 v[198:199], v3 offset:17408
buffer_load_dwordx4 v[88:91], v8, s[8:11], s34 offen offset:2048 sc1
s_waitcnt vmcnt(5) lgkmcnt(4)
v_mfma_f32_32x32x16_bf16 v[160:175], v[200:203], v[68:71], v[160:175]
v_mfma_f32_32x32x16_bf16 v[176:191], v[204:207], v[68:71], v[176:191]
ds_read_b64_tr_b16 v[200:201], v2 offset:24576
ds_read_b64_tr_b16 v[202:203], v2 offset:25600
ds_read_b64_tr_b16 v[204:205], v3 offset:24576
ds_read_b64_tr_b16 v[206:207], v3 offset:25600
buffer_load_dwordx4 v[92:95], v8, s[8:11], s34 offen offset:3072 sc1
s_add_u32 s34, s34, 4096
s_waitcnt vmcnt(5) lgkmcnt(4)
v_mfma_f32_32x32x16_bf16 v[160:175], v[192:195], v[72:75], v[160:175]
v_mfma_f32_32x32x16_bf16 v[176:191], v[196:199], v[72:75], v[176:191]
ds_read_b64_tr_b16 v[192:193], v2 offset:32768
ds_read_b64_tr_b16 v[194:195], v2 offset:33792
ds_read_b64_tr_b16 v[196:197], v3 offset:32768
ds_read_b64_tr_b16 v[198:199], v3 offset:33792
buffer_load_dwordx4 v[96:99], v8, s[8:11], s34 offen offset:0 sc1
s_waitcnt vmcnt(5) lgkmcnt(4)
v_mfma_f32_32x32x16_bf16 v[160:175], v[200:203], v[76:79], v[160:175]
v_mfma_f32_32x32x16_bf16 v[176:191], v[204:207], v[76:79], v[176:191]
ds_read_b64_tr_b16 v[200:201], v2 offset:40960
ds_read_b64_tr_b16 v[202:203], v2 offset:41984
ds_read_b64_tr_b16 v[204:205], v3 offset:40960
ds_read_b64_tr_b16 v[206:207], v3 offset:41984
buffer_load_dwordx4 v[100:103], v8, s[8:11], s34 offen offset:1024 sc1
s_waitcnt vmcnt(5) lgkmcnt(4)
v_mfma_f32_32x32x16_bf16 v[160:175], v[192:195], v[80:83], v[160:175]
v_mfma_f32_32x32x16_bf16 v[176:191], v[196:199], v[80:83], v[176:191]
ds_read_b64_tr_b16 v[192:193], v2 offset:49152
ds_read_b64_tr_b16 v[194:195], v2 offset:50176
ds_read_b64_tr_b16 v[196:197], v3 offset:49152
ds_read_b64_tr_b16 v[198:199], v3 offset:50176
buffer_load_dwordx4 v[104:107], v8, s[8:11], s34 offen offset:2048 sc1
s_waitcnt vmcnt(5) lgkmcnt(4)
v_mfma_f32_32x32x16_bf16 v[160:175], v[200:203], v[84:87], v[160:175]
v_mfma_f32_32x32x16_bf16 v[176:191], v[204:207], v[84:87], v[176:191]
ds_read_b64_tr_b16 v[200:201], v2 offset:57344
ds_read_b64_tr_b16 v[202:203], v2 offset:58368
ds_read_b64_tr_b16 v[204:205], v3 offset:57344
ds_read_b64_tr_b16 v[206:207], v3 offset:58368
buffer_load_dwordx4 v[108:111], v8, s[8:11], s34 offen offset:3072 sc1
s_add_u32 s34, s34, 4096
s_waitcnt vmcnt(5) lgkmcnt(4)
v_mfma_f32_32x32x16_bf16 v[160:175], v[192:195], v[88:91], v[160:175]
v_mfma_f32_32x32x16_bf16 v[176:191], v[196:199], v[88:91], v[176:191]
ds_read_b64_tr_b16 v[192:193], v4 offset:0
ds_read_b64_tr_b16 v[194:195], v4 offset:1024
ds_read_b64_tr_b16 v[196:197], v5 offset:0
ds_read_b64_tr_b16 v[198:199], v5 offset:1024
buffer_load_dwordx4 v[112:115], v8, s[8:11], s34 offen offset:0 sc1
s_waitcnt vmcnt(5) lgkmcnt(4)
v_mfma_f32_32x32x16_bf16 v[160:175], v[200:203], v[92:95], v[160:175]
v_mfma_f32_32x32x16_bf16 v[176:191], v[204:207], v[92:95], v[176:191]
ds_read_b64_tr_b16 v[200:201], v4 offset:8192
ds_read_b64_tr_b16 v[202:203], v4 offset:9216
ds_read_b64_tr_b16 v[204:205], v5 offset:8192
ds_read_b64_tr_b16 v[206:207], v5 offset:9216
buffer_load_dwordx4 v[116:119], v8, s[8:11], s34 offen offset:1024 sc1
s_waitcnt vmcnt(5) lgkmcnt(4)
v_mfma_f32_32x32x16_bf16 v[160:175], v[192:195], v[96:99], v[160:175]
v_mfma_f32_32x32x16_bf16 v[176:191], v[196:199], v[96:99], v[176:191]
ds_read_b64_tr_b16 v[192:193], v4 offset:16384
ds_read_b64_tr_b16 v[194:195], v4 offset:17408
ds_read_b64_tr_b16 v[196:197], v5 offset:16384
ds_read_b64_tr_b16 v[198:199], v5 offset:17408
buffer_load_dwordx4 v[120:123], v8, s[8:11], s34 offen offset:2048 sc1
s_waitcnt vmcnt(5) lgkmcnt(4)
v_mfma_f32_32x32x16_bf16 v[160:175], v[200:203], v[100:103], v[160:175]
v_mfma_f32_32x32x16_bf16 v[176:191], v[204:207], v[100:103], v[176:191]
ds_read_b64_tr_b16 v[200:201], v4 offset:24576
ds_read_b64_tr_b16 v[202:203], v4 offset:25600
ds_read_b64_tr_b16 v[204:205], v5 offset:24576
ds_read_b64_tr_b16 v[206:207], v5 offset:25600
buffer_load_dwordx4 v[124:127], v8, s[8:11], s34 offen offset:3072 sc1
s_add_u32 s34, s34, 4096
s_waitcnt vmcnt(5) lgkmcnt(4)
v_mfma_f32_32x32x16_bf16 v[160:175], v[192:195], v[104:107], v[160:175]
v_mfma_f32_32x32x16_bf16 v[176:191], v[196:199], v[104:107], v[176:191]
ds_read_b64_tr_b16 v[192:193], v4 offset:32768
ds_read_b64_tr_b16 v[194:195], v4 offset:33792
ds_read_b64_tr_b16 v[196:197], v5 offset:32768
ds_read_b64_tr_b16 v[198:199], v5 offset:33792
buffer_load_dwordx4 v[128:131], v8, s[8:11], s34 offen offset:0 sc1
s_waitcnt vmcnt(5) lgkmcnt(4)
v_mfma_f32_32x32x16_bf16 v[160:175], v[200:203], v[108:111], v[160:175]
v_mfma_f32_32x32x16_bf16 v[176:191], v[204:207], v[108:111], v[176:191]
ds_read_b64_tr_b16 v[200:201], v4 offset:40960
ds_read_b64_tr_b16 v[202:203], v4 offset:41984
ds_read_b64_tr_b16 v[204:205], v5 offset:40960
ds_read_b64_tr_b16 v[206:207], v5 offset:41984
buffer_load_dwordx4 v[132:135], v8, s[8:11], s34 offen offset:1024 sc1
s_waitcnt vmcnt(5) lgkmcnt(4)
v_mfma_f32_32x32x16_bf16 v[160:175], v[192:195], v[112:115], v[160:175]
v_mfma_f32_32x32x16_bf16 v[176:191], v[196:199], v[112:115], v[176:191]
ds_read_b64_tr_b16 v[192:193], v4 offset:49152
ds_read_b64_tr_b16 v[194:195], v4 offset:50176
ds_read_b64_tr_b16 v[196:197], v5 offset:49152
ds_read_b64_tr_b16 v[198:199], v5 offset:50176
buffer_load_dwordx4 v[136:139], v8, s[8:11], s34 offen offset:2048 sc1
s_waitcnt vmcnt(5) lgkmcnt(4)
v_mfma_f32_32x32x16_bf16 v[160:175], v[200:203], v[116:119], v[160:175]
v_mfma_f32_32x32x16_bf16 v[176:191], v[204:207], v[116:119], v[176:191]
ds_read_b64_tr_b16 v[200:201], v4 offset:57344
ds_read_b64_tr_b16 v[202:203], v4 offset:58368
ds_read_b64_tr_b16 v[204:205], v5 offset:57344
ds_read_b64_tr_b16 v[206:207], v5 offset:58368
buffer_load_dwordx4 v[140:143], v8, s[8:11], s34 offen offset:3072 sc1
s_add_u32 s34, s34, 4096
s_waitcnt vmcnt(5) lgkmcnt(4)
v_mfma_f32_32x32x16_bf16 v[160:175], v[192:195], v[120:123], v[160:175]
v_mfma_f32_32x32x16_bf16 v[176:191], v[196:199], v[120:123], v[176:191]
ds_read_b64_tr_b16 v[192:193], v6 offset:0
ds_read_b64_tr_b16 v[194:195], v6 offset:1024
ds_read_b64_tr_b16 v[196:197], v7 offset:0
ds_read_b64_tr_b16 v[198:199], v7 offset:1024
buffer_load_dwordx4 v[144:147], v8, s[8:11], s34 offen offset:0 sc1
s_waitcnt vmcnt(5) lgkmcnt(4)
v_mfma_f32_32x32x16_bf16 v[160:175], v[200:203], v[124:127], v[160:175]
v_mfma_f32_32x32x16_bf16 v[176:191], v[204:207], v[124:127], v[176:191]
ds_read_b64_tr_b16 v[200:201], v6 offset:8192
ds_read_b64_tr_b16 v[202:203], v6 offset:9216
ds_read_b64_tr_b16 v[204:205], v7 offset:8192
ds_read_b64_tr_b16 v[206:207], v7 offset:9216
buffer_load_dwordx4 v[148:151], v8, s[8:11], s34 offen offset:1024 sc1
s_waitcnt vmcnt(5) lgkmcnt(4)
v_mfma_f32_32x32x16_bf16 v[160:175], v[192:195], v[128:131], v[160:175]
v_mfma_f32_32x32x16_bf16 v[176:191], v[196:199], v[128:131], v[176:191]
ds_read_b64_tr_b16 v[192:193], v6 offset:16384
ds_read_b64_tr_b16 v[194:195], v6 offset:17408
ds_read_b64_tr_b16 v[196:197], v7 offset:16384
ds_read_b64_tr_b16 v[198:199], v7 offset:17408
s_waitcnt vmcnt(4) lgkmcnt(4)
v_mfma_f32_32x32x16_bf16 v[160:175], v[200:203], v[132:135], v[160:175]
v_mfma_f32_32x32x16_bf16 v[176:191], v[204:207], v[132:135], v[176:191]
ds_read_b64_tr_b16 v[200:201], v6 offset:24576
ds_read_b64_tr_b16 v[202:203], v6 offset:25600
ds_read_b64_tr_b16 v[204:205], v7 offset:24576
ds_read_b64_tr_b16 v[206:207], v7 offset:25600
s_waitcnt vmcnt(3) lgkmcnt(4)
v_mfma_f32_32x32x16_bf16 v[160:175], v[192:195], v[136:139], v[160:175]
v_mfma_f32_32x32x16_bf16 v[176:191], v[196:199], v[136:139], v[176:191]
s_waitcnt vmcnt(2) lgkmcnt(0)
v_mfma_f32_32x32x16_bf16 v[160:175], v[200:203], v[140:143], v[160:175]
v_mfma_f32_32x32x16_bf16 v[176:191], v[204:207], v[140:143], v[176:191]
s_waitcnt vmcnt(1) lgkmcnt(0)
v_mfma_f32_32x32x16_bf16 v[160:175], v[24:27], v[144:147], v[160:175]
v_mfma_f32_32x32x16_bf16 v[176:191], v[28:31], v[144:147], v[176:191]
s_waitcnt vmcnt(0) lgkmcnt(0)
s_cmp_ge_u32 s27, 2
s_cbranch_scc1 L_g_76
v_mfma_f32_32x32x16_bf16 v[160:175], v[32:35], v[148:151], v[160:175]
v_mfma_f32_32x32x16_bf16 v[176:191], v[36:39], v[148:151], v[176:191]
L_g_76:
s_nop 15
s_barrier
s_lshl_b32 s36, s26, 15
s_lshl_b32 s37, s27, 11
s_add_u32 s36, s36, s37
v_add_u32 v9, s36, v8
ds_write_b128 v9, v[160:163] offset:0
ds_write_b128 v9, v[164:167] offset:1024
ds_write_b128 v9, v[168:171] offset:8192
ds_write_b128 v9, v[172:175] offset:9216
ds_write_b128 v9, v[176:179] offset:16384
ds_write_b128 v9, v[180:183] offset:17408
ds_write_b128 v9, v[184:187] offset:24576
ds_write_b128 v9, v[188:191] offset:25600
s_waitcnt vmcnt(0)
v_lshlrev_b32 v208, 16, v248
v_and_b32 v209, 0xffff0000, v248
v_lshlrev_b32 v210, 16, v249
v_and_b32 v211, 0xffff0000, v249
v_lshlrev_b32 v212, 16, v250
v_and_b32 v213, 0xffff0000, v250
v_lshlrev_b32 v214, 16, v251
v_and_b32 v215, 0xffff0000, v251
v_lshlrev_b32 v216, 16, v236
v_and_b32 v217, 0xffff0000, v236
v_lshlrev_b32 v218, 16, v237
v_and_b32 v219, 0xffff0000, v237
v_lshlrev_b32 v220, 16, v238
v_and_b32 v221, 0xffff0000, v238
v_lshlrev_b32 v222, 16, v239
v_and_b32 v223, 0xffff0000, v239
v_add_f32 v208, v208, v216
v_add_f32 v209, v209, v217
v_add_f32 v210, v210, v218
v_add_f32 v211, v211, v219
v_add_f32 v212, v212, v220
v_add_f32 v213, v213, v221
v_add_f32 v214, v214, v222
v_add_f32 v215, v215, v223
s_waitcnt lgkmcnt(0)
s_barrier
s_lshl_b32 s36, s26, 15
s_lshl_b32 s37, s27, 13
s_add_u32 s36, s36, s37
v_add_u32 v9, s36, v8
ds_read_b128 v[64:67], v9 offset:0
ds_read_b128 v[68:71], v9 offset:1024
ds_read_b128 v[72:75], v9 offset:2048
ds_read_b128 v[76:79], v9 offset:3072
ds_read_b128 v[80:83], v9 offset:4096
ds_read_b128 v[84:87], v9 offset:5120
ds_read_b128 v[88:91], v9 offset:6144
ds_read_b128 v[92:95], v9 offset:7168
s_waitcnt lgkmcnt(4)
v_add_f32 v64, v64, v72
v_add_f32 v64, v64, v208
v_add_f32 v65, v65, v73
v_add_f32 v65, v65, v209
v_add_f32 v66, v66, v74
v_add_f32 v66, v66, v210
v_add_f32 v67, v67, v75
v_add_f32 v67, v67, v211
v_add_f32 v68, v68, v76
v_add_f32 v68, v68, v212
v_add_f32 v69, v69, v77
v_add_f32 v69, v69, v213
v_add_f32 v70, v70, v78
v_add_f32 v70, v70, v214
v_add_f32 v71, v71, v79
v_add_f32 v71, v71, v215
s_waitcnt lgkmcnt(0)
v_add_f32 v80, v80, v88
v_add_f32 v64, v64, v80
v_add_f32 v81, v81, v89
v_add_f32 v65, v65, v81
v_add_f32 v82, v82, v90
v_add_f32 v66, v66, v82
v_add_f32 v83, v83, v91
v_add_f32 v67, v67, v83
v_add_f32 v84, v84, v92
v_add_f32 v68, v68, v84
v_add_f32 v85, v85, v93
v_add_f32 v69, v69, v85
v_add_f32 v86, v86, v94
v_add_f32 v70, v70, v86
v_add_f32 v87, v87, v95
v_add_f32 v71, v71, v87
v_cvt_pk_bf16_f32 v224, v64, v65
v_cvt_pk_bf16_f32 v225, v66, v67
v_cvt_pk_bf16_f32 v226, v68, v69
v_cvt_pk_bf16_f32 v227, v70, v71
s_nop 1
v_permlane32_swap_b32 v224, v226
v_permlane32_swap_b32 v225, v227
v_lshlrev_b32 v17, 10, v16
v_lshlrev_b32 v18, 4, v15
v_add_u32 v17, v17, v18
s_lshl_b32 s35, s28, 15
s_lshl_b32 s36, s4, 7
s_add_u32 s35, s35, s36
s_lshl_b32 s36, s27, 5
s_add_u32 s35, s35, s36
s_nop 0
buffer_store_dwordx4 v[224:227], v17, s[20:23], s35 offen
L_exit:
s_endpgm
L_codeend:
.section .rodata,"a"
.p2align 6
.amdhsa_kernel sequential_preLN__sliding_block__dense_activation_gelu__prompt_kernel
.amdhsa_next_free_vgpr 256
.amdhsa_next_free_sgpr 102
.amdhsa_accum_offset 256
.amdhsa_group_segment_fixed_size 0
.amdhsa_kernarg_size 88
.amdhsa_user_sgpr_count 2
.amdhsa_user_sgpr_kernarg_segment_ptr 1
.amdhsa_system_sgpr_workgroup_id_x 1
.end_amdhsa_kernel
```
